```python
import torch

def _softmax(x, axis=-1):
    return torch.softmax(x, dim=axis)
def _gelu(x):
    return torch.nn.functional.gelu(x, approximate="tanh")
def _silu(x):
    return torch.nn.functional.silu(x)
def _sigmoid(x):
    return torch.sigmoid(x)
def _layernorm(x, axis=-1, eps=1e-5):
    m = x.mean(dim=axis, keepdim=True)
    v = x.var(dim=axis, keepdim=True, unbiased=False)
    return (x - m) / torch.sqrt(v + eps)
def _scatter_add(tgt, idx, src, axis=0):
    return tgt.clone().index_add_(axis, idx, src)
def _segment_sum(src, seg, n):
    out = torch.zeros((n,) + src.shape[1:], dtype=src.dtype)
    return out.index_add_(0, seg, src)
def _pad(x, pw):
    flat = tuple(v for pair in reversed(pw) for v in pair)
    return torch.nn.functional.pad(x, flat)

kernel_name = 'recurrent_scan__sliding_local_dilated__mixer_channel_mlp__prompt'

def setup_inputs():

    _w = (lambda a: (lambda t: t.to(torch.bfloat16) if t.is_floating_point() else t)(torch.as_tensor(a)))
    def _A_setup():
        B, S, D = 1, 2048, 448
        return {
            "x": _w((lambda *s: torch.randn(*s, dtype=torch.bfloat16) * 0.05)(B, S, D)),
            "wqkv": _w((lambda *s: torch.randn(*s, dtype=torch.bfloat16) * 0.05)(D, 3 * D)),
            "wo": _w((lambda *s: torch.randn(*s, dtype=torch.bfloat16) * 0.05)(D, D)),
        }
    _A_in = _A_setup()

    def _B_setup():
        B, S, D, F = 1, 2048, 448, 1792
        return {
            "x": _w((lambda *s: torch.randn(*s, dtype=torch.bfloat16) * 0.05)(B, S, D)),
            "w1": _w((lambda *s: torch.randn(*s, dtype=torch.bfloat16) * 0.8)(D, F) * (D ** -0.5)),
            "b1": _w((lambda *s: torch.randn(*s, dtype=torch.bfloat16) * 0.4)(F)),
            "w2": _w((lambda *s: torch.randn(*s, dtype=torch.bfloat16) * 0.05)(F, D) * (F ** -0.5)),
            "b2": _w((lambda *s: torch.randn(*s, dtype=torch.bfloat16) * 0.05)(D)),
        }
    _B_in = _B_setup()

    return {
        "A_x": _A_in["x"],
        "A_wqkv": _A_in["wqkv"],
        "A_wo": _A_in["wo"],
        "B_x": _B_in["x"],
        "B_w1": _B_in["w1"],
        "B_b1": _B_in["b1"],
        "B_w2": _B_in["w2"],
        "B_b2": _B_in["b2"],
    }

def reference(A_x, A_wqkv, A_wo, B_x, B_w1, B_b1, B_w2, B_b2):
    def _A_ref(x, wqkv, wo):
        B, S, D = x.shape
        H = 16; Dh = D // H
        W, dil = 8, 2
        qkv = (lambda x, *d: x.permute(*d))((x @ wqkv).reshape(B, S, 3, H, Dh), 2, 0, 3, 1, 4)
        q, k, v = qkv[0], qkv[1], qkv[2]
        scale = Dh ** -0.5
        pos = torch.arange(S)
        off = torch.arange(W) * dil
        idx = pos[:, None] - off[None, :]
        mask = idx >= 0
        idx_c = torch.where(mask, idx, 0).reshape(-1)
        kg = k[:, :, idx_c, :].reshape(B, H, S, W, Dh)
        vg = v[:, :, idx_c, :].reshape(B, H, S, W, Dh)
        logits = torch.einsum("bhsd,bhswd->bhsw", q, kg) * scale
        logits = torch.where(mask[None, None, :, :], logits, -1e9)
        attn = _softmax(logits, axis=-1)
        o = torch.einsum("bhsw,bhswd->bhsd", attn, vg)
        return (lambda x, *d: x.permute(*d))(o, 0, 2, 1, 3).reshape(B, S, D) @ wo

    def _B_ref(x, w1, b1, w2, b2):
        y = _layernorm(x, axis=-1)
        h = _gelu(torch.einsum("bsd,df->bsf", y, w1) + b1)
        return torch.einsum("bsf,fd->bsd", h, w2) + b2

    x = A_x
    xn = _layernorm(x, axis=-1)
    s = _A_ref(xn, A_wqkv, A_wo)
    g = _silu(_B_ref(xn, B_w1, B_b1, B_w2, B_b2))
    return x + s * g
```

```asm
; @launch grid=(256,1,1) block=(512,1,1) lds=163840
.amdgcn_target "amdgcn-amd-amdhsa--gfx950"
.text
.globl recurrent_scan__sliding_local_dilated__mixer_channel_mlp__prompt_kernel
.p2align 8
.type recurrent_scan__sliding_local_dilated__mixer_channel_mlp__prompt_kernel,@function
recurrent_scan__sliding_local_dilated__mixer_channel_mlp__prompt_kernel:
    s_load_dwordx16 s[4:19], s[0:1], 0
    s_load_dwordx4 s[20:23], s[0:1], 64
    s_load_dwordx2 s[24:25], s[0:1], 80
    s_cmp_ge_u32 s2, 256
    s_cbranch_scc1 L_end
    v_lshrrev_b32 v2, 6, v0
    v_and_b32 v1, 63, v0
    v_readfirstlane_b32 s64, v2
    s_and_b32 s65, s2, 7
    s_lshr_b32 s66, s2, 3
    s_sub_u32 s69, s66, 0
    s_cmp_lt_u32 s69, 5
    s_cbranch_scc0 L_nocpf
    s_cmp_eq_u32 s64, 7
    s_cbranch_scc0 L_nocpf
    s_getpc_b64 s[94:95]
L_pc0:
    s_sub_u32 s94, s94, L_pc0-recurrent_scan__sliding_local_dilated__mixer_channel_mlp__prompt_kernel
    s_subb_u32 s95, s95, 0
    s_lshl_b32 s69, s69, 13
    v_lshlrev_b32 v250, 7, v1
    v_add_u32 v250, s69, v250
    v_min_u32 v250, L_code_end-recurrent_scan__sliding_local_dilated__mixer_channel_mlp__prompt_kernel-4, v250
    global_load_dword v250, v250, s[94:95]
L_nocpf:
    s_lshr_b32 s69, s65, 2
    s_lshl_b32 s69, s69, 3
    s_bfe_u32 s70, s66, 196609
    s_add_u32 s67, s69, s70
    s_and_b32 s69, s65, 3
    s_lshl_b32 s69, s69, 1
    s_and_b32 s70, s66, 1
    s_add_u32 s68, s69, s70
    s_lshl_b32 s72, s64, 11
    s_lshl_b32 s73, s64, 10
    s_lshl_b32 s69, s67, 7
    s_lshl_b32 s70, s64, 4
    s_add_u32 s69, s69, s70
    v_lshrrev_b32 v244, 3, v1
    v_add_u32 v244, s69, v244
    v_mul_u32_u24 v244, 896, v244
    v_lshrrev_b32 v245, 4, v1
    v_xor_b32 v245, v245, v1
    v_and_b32 v245, 7, v245
    v_lshl_add_u32 v2, v245, 4, v244
    v_xor_b32 v245, 4, v245
    v_add_u32 v244, 7168, v244
    v_lshl_add_u32 v3, v245, 4, v244
    s_lshr_b32 s71, s66, 4
    s_bfe_u32 s69, s66, 0x30001
    s_and_b32 s70, s66, 1
    s_lshl_b32 s70, s70, 1
    s_add_u32 s69, s69, s70
    s_lshl_b32 s70, s71, 2
    s_add_u32 s69, s69, s70
    s_sub_u32 s70, s69, 7
    s_cmp_ge_u32 s69, 7
    s_cselect_b32 s69, s70, s69
    s_lshl_b32 s3, s69, 7
    s_mul_i32 s71, s71, 81920
    s_add_u32 s71, s71, s72
    s_waitcnt lgkmcnt(0)
    s_mov_b32 s28, s4
    s_mov_b32 s29, s5
    s_mov_b32 s30, 1835008
    s_mov_b32 s31, 0x20000
    s_mov_b32 s4, s3
    s_mov_b32 m0, s71
    s_nop 0
    buffer_load_dwordx4 v2, s[28:31], s4 offen lds
    s_add_u32 m0, s71, 1024
    s_nop 0
    buffer_load_dwordx4 v3, s[28:31], s4 offen lds
    s_mul_i32 s69, s66, 37
    s_lshr_b32 s69, s69, 8
    s_mul_i32 s70, s69, 7
    s_sub_u32 s91, s66, s70
    s_lshl_b32 s90, s65, 2
    s_add_u32 s90, s90, s69
    s_lshr_b32 s69, s90, 1
    s_and_b32 s69, s69, 15
    s_lshl_b32 s69, s69, 7
    s_add_u32 s92, s69, 9437184
    s_add_u32 s93, s69, 9439232
    s_cmp_ge_u32 s66, 16
    s_cbranch_scc1 L_att
    v_lshrrev_b32 v224, 3, v1
    s_lshl_b32 s69, s64, 3
    v_add_u32 v224, s69, v224
    v_mul_u32_u24 v224, 3584, v224
    v_lshrrev_b32 v225, 2, v1
    v_and_b32 v225, 4, v225
    v_xor_b32 v225, v225, v1
    v_and_b32 v225, 7, v225
    v_lshl_add_u32 v4, v225, 4, v224
    s_lshr_b32 s27, s64, 2
    s_and_b32 s26, s64, 3
    s_and_b32 s71, s68, 1
    s_mul_i32 s69, s68, 448
    s_lshl_b32 s70, s71, 6
    s_add_u32 s74, s69, s70
    s_add_u32 s75, s69, 384
    s_sub_u32 s79, s69, 64
    s_cmp_eq_u32 s71, 0
    s_cselect_b32 s75, s75, s79
    s_add_u32 s79, s75, s70
    s_mov_b32 s75, s69
    v_add_u32 v4, s70, v4
    s_nop 0
    s_mov_b32 s32, s12
    s_mov_b32 s33, s13
    s_mov_b32 s34, 1605632
    s_mov_b32 s35, 0x20000
    s_add_u32 s5, s4, 128
    s_cmp_eq_u32 s5, 896
    s_cselect_b32 s5, 0, s5
    s_add_u32 s6, s5, 128
    s_cmp_eq_u32 s6, 896
    s_cselect_b32 s6, 0, s6
    s_add_u32 s7, s6, 128
    s_cmp_eq_u32 s7, 896
    s_cselect_b32 s7, 0, s7
    s_add_u32 s10, s7, 128
    s_cmp_eq_u32 s10, 896
    s_cselect_b32 s10, 0, s10
    s_add_u32 s11, s10, 128
    s_cmp_eq_u32 s11, 896
    s_cselect_b32 s11, 0, s11
    s_add_u32 s12, s11, 128
    s_cmp_eq_u32 s12, 896
    s_cselect_b32 s12, 0, s12
    s_add_u32 m0, s73, 114688
    s_mul_i32 s69, s4, 1792
    s_add_u32 s69, s69, s75
    buffer_load_dwordx4 v4, s[32:35], s69 offen offset:0 lds
    s_barrier
    s_mov_b32 s36, s24
    s_mov_b32 s37, s25
    s_mov_b32 s38, 9699328
    s_mov_b32 s39, 0x20000
    s_mov_b32 s60, s22
    s_mov_b32 s61, s23
    s_mov_b32 s62, 256
    s_mov_b32 s63, 0x20000
    s_or_b32 s69, s2, s64
    s_cmp_eq_u32 s69, 0
    s_cbranch_scc0 L_noinit
    v_lshlrev_b32 v224, 7, v1
    v_mov_b32 v225, 0
    s_mov_b32 s69, 9437184
    buffer_store_dword v225, v224, s[36:39], s69 offen sc1
    s_mov_b32 s69, 9445376
    buffer_store_dword v225, v224, s[36:39], s69 offen sc1
    s_mov_b32 s69, 9453568
    buffer_store_dword v225, v224, s[36:39], s69 offen sc1
L_noinit:
    s_add_u32 m0, s72, 16384
    s_nop 0
    buffer_load_dwordx4 v2, s[28:31], s5 offen lds
    s_add_u32 m0, s72, 17408
    s_nop 0
    buffer_load_dwordx4 v3, s[28:31], s5 offen lds
    s_add_u32 m0, s73, 122880
    s_mul_i32 s69, s5, 1792
    s_add_u32 s69, s69, s75
    buffer_load_dwordx4 v4, s[32:35], s69 offen offset:0 lds
    s_mov_b32 s40, s14
    s_mov_b32 s41, s15
    s_mov_b32 s42, 3584
    s_mov_b32 s43, 0x20000
    s_lshl_b32 s69, s67, 2
    s_add_u32 s69, s69, s26
    s_mul_i32 s69, s69, 114688
    s_lshl_b32 s71, s79, 5
    s_add_u32 s77, s69, s71
    s_lshl_b32 s71, s27, 6
    s_add_u32 s78, s74, s71
    s_lshl_b32 s71, s78, 5
    s_add_u32 s76, s69, s71
    v_and_b32 v228, 31, v1
    v_lshlrev_b32 v229, 1, v228
    s_xor_b32 s71, s27, s26
    v_and_b32 v224, 31, v1
    s_lshl_b32 s69, s26, 5
    v_add_u32 v224, s69, v224
    v_bfe_u32 v225, v1, 1, 3
    v_lshrrev_b32 v226, 5, v1
    v_xor_b32 v225, v225, v226
    v_lshlrev_b32 v225, 4, v225
    v_lshl_add_u32 v225, v224, 7, v225
    s_lshl_b32 s69, s71, 5
    v_xor_b32 v18, s69, v225
    v_xor_b32 v19, 32, v18
    v_xor_b32 v20, 64, v18
    v_xor_b32 v21, 0x60, v18
    v_lshlrev_b32 v226, 3, v226
    v_bfe_u32 v225, v1, 2, 2
    v_add_u32 v226, v226, v225
    v_lshlrev_b32 v226, 7, v226
    v_and_b32 v225, 16, v1
    v_lshlrev_b32 v225, 1, v225
    v_and_b32 v227, 3, v1
    v_lshl_add_u32 v225, v227, 3, v225
    s_mul_i32 s69, s27, 64
    v_add_u32 v225, s69, v225
    v_and_b32 v227, 8, v1
    v_lshlrev_b32 v227, 3, v227
    v_xor_b32 v225, v225, v227
    v_add_u32 v226, v226, v225
    s_lshl_b32 s69, s71, 11
    v_xor_b32 v6, s69, v226
    v_xor_b32 v7, 0x800, v6
    v_xor_b32 v8, 0x1000, v6
    v_xor_b32 v9, 0x1800, v6
    v_add_u32 v10, 65536, v6
    v_add_u32 v11, 65536, v7
    v_add_u32 v12, 65536, v8
    v_add_u32 v13, 65536, v9
    v_add_u32 v14, 131072, v6
    v_add_u32 v15, 131072, v7
    v_add_u32 v16, 131072, v8
    v_add_u32 v17, 131072, v9
    v_lshlrev_b32 v22, 4, v1
    s_lshl_b32 s71, s27, 9
    s_add_u32 s71, s71, 159744
    v_lshlrev_b32 v215, 4, v228
    v_add_u32 v215, s71, v215
    s_lshl_b32 s71, s26, 2
    v_add_u32 v23, s71, v215
    v_lshlrev_b32 v224, 3, v224
    s_lshl_b32 s71, s27, 10
    s_add_u32 s71, s71, 161792
    v_add_u32 v216, s71, v224
    v_xor_b32 v217, 0x400, v216
    v_mov_b32 v207, 0
    v_mov_b32 v203, 0
    v_mov_b32 v218, 0
    v_mov_b32 v219, 0
    v_lshrrev_b32 v224, 2, v1
    v_lshrrev_b32 v225, 4, v1
    v_xor_b32 v224, v224, v225
    v_and_b32 v224, 1, v224
    v_add_u32 v224, -1, v224
    v_and_b32 v196, 0x3f803f80, v224
    v_mov_b32 v197, v196
    v_mov_b32 v198, v196
    v_mov_b32 v199, v196
    v_mov_b32 v245, 0x3f803f80
    v_mov_b32 v220, 0
    v_mov_b32 v221, 0
    v_mov_b32 v192, 0
    v_mov_b32 v193, 0
    s_lshr_b32 s71, s64, 1
    s_and_b32 s70, s64, 1
    v_lshrrev_b32 v224, 3, v1
    s_lshl_b32 s69, s70, 3
    v_add_u32 v224, s69, v224
    v_mul_u32_u24 v224, 896, v224
    v_lshrrev_b32 v225, 2, v1
    v_and_b32 v225, 4, v225
    v_xor_b32 v225, v225, v1
    v_and_b32 v225, 7, v225
    v_lshl_add_u32 v249, v225, 4, v224
    s_lshl_b32 s69, s91, 7
    v_add_u32 v249, s69, v249
    s_lshl_b32 s69, s71, 14
    s_lshl_b32 s70, s70, 10
    s_add_u32 s98, s69, s70
    s_mul_i32 s99, s71, 401408
    s_and_b32 s69, s90, 3
    s_lshl_b32 s69, s69, 1
    s_and_b32 s70, s65, 1
    s_add_u32 s69, s69, s70
    s_lshl_b32 s69, s69, 11
    s_add_u32 s0, s69, 0
    s_and_b32 s0, s0, 0x3fff
    s_and_b32 s70, s0, 0x2000
    s_mul_i32 s70, s70, 3
    s_add_u32 s70, s70, s0
    s_mul_i32 s70, s70, 7
    s_add_u32 s80, s70, s99
    s_add_u32 s1, s69, 2048
    s_and_b32 s1, s1, 0x3fff
    s_and_b32 s70, s1, 0x2000
    s_mul_i32 s70, s70, 3
    s_add_u32 s70, s70, s1
    s_mul_i32 s70, s70, 7
    s_add_u32 s81, s70, s99
    s_add_u32 s3, s69, 4096
    s_and_b32 s3, s3, 0x3fff
    s_and_b32 s70, s3, 0x2000
    s_mul_i32 s70, s70, 3
    s_add_u32 s70, s70, s3
    s_mul_i32 s70, s70, 7
    s_add_u32 s82, s70, s99
    s_add_u32 s13, s69, 6144
    s_and_b32 s13, s13, 0x3fff
    s_and_b32 s70, s13, 0x2000
    s_mul_i32 s70, s70, 3
    s_add_u32 s70, s70, s13
    s_mul_i32 s70, s70, 7
    s_add_u32 s83, s70, s99
    s_add_u32 s14, s69, 8192
    s_and_b32 s14, s14, 0x3fff
    s_and_b32 s70, s14, 0x2000
    s_mul_i32 s70, s70, 3
    s_add_u32 s70, s70, s14
    s_mul_i32 s70, s70, 7
    s_add_u32 s84, s70, s99
    s_add_u32 s15, s69, 10240
    s_and_b32 s15, s15, 0x3fff
    s_and_b32 s70, s15, 0x2000
    s_mul_i32 s70, s70, 3
    s_add_u32 s70, s70, s15
    s_mul_i32 s70, s70, 7
    s_add_u32 s85, s70, s99
    s_add_u32 s22, s69, 12288
    s_and_b32 s22, s22, 0x3fff
    s_and_b32 s70, s22, 0x2000
    s_mul_i32 s70, s70, 3
    s_add_u32 s70, s70, s22
    s_mul_i32 s70, s70, 7
    s_add_u32 s86, s70, s99
    s_add_u32 s23, s69, 14336
    s_and_b32 s23, s23, 0x3fff
    s_and_b32 s70, s23, 0x2000
    s_mul_i32 s70, s70, 3
    s_add_u32 s70, s70, s23
    s_mul_i32 s70, s70, 7
    s_add_u32 s87, s70, s99
    v_lshrrev_b32 v224, 2, v1
    s_lshl_b32 s69, s64, 3
    v_add_u32 v224, s69, v224
    v_mul_u32_u24 v224, 3584, v224
    v_and_b32 v225, 3, v1
    v_lshl_add_u32 v5, v225, 4, v224
    s_sub_u32 s69, s79, s75
    v_add_u32 v5, s69, v5
    s_lshr_b32 s59, s73, 1
    s_mul_i32 s52, s4, 1792
    s_add_u32 s52, s52, s75
    s_mul_i32 s53, s5, 1792
    s_add_u32 s53, s53, s75
    s_mul_i32 s54, s6, 1792
    s_add_u32 s54, s54, s75
    s_mul_i32 s55, s7, 1792
    s_add_u32 s55, s55, s75
    s_mul_i32 s56, s10, 1792
    s_add_u32 s56, s56, s75
    s_mul_i32 s57, s11, 1792
    s_add_u32 s57, s57, s75
    s_mul_i32 s58, s12, 1792
    s_add_u32 s58, s58, s75
    v_lshlrev_b32 v244, 7, v1
    buffer_load_ushort v211, v229, s[40:43], s78 offen offset:0
    buffer_load_ushort v212, v229, s[40:43], s78 offen offset:128
    buffer_load_ushort v213, v229, s[40:43], s78 offen offset:256
    buffer_load_ushort v214, v229, s[40:43], s79 offen
    s_branch L_mlp_body
L_att:
    v_lshrrev_b32 v15, 3, v1
    s_lshl_b32 s69, s64, 3
    v_add_u32 v15, s69, v15
    v_mul_u32_u24 v15, 2688, v15
    v_lshrrev_b32 v16, 2, v1
    v_and_b32 v16, 4, v16
    v_xor_b32 v16, v16, v1
    v_and_b32 v16, 7, v16
    v_min_u32 v16, 6, v16
    v_lshl_add_u32 v4, v16, 4, v15
    s_and_b32 s74, s64, 3
    s_lshr_b32 s75, s64, 2
    s_and_b32 s71, s64, 1
    s_lshl_b32 s69, s67, 7
    s_lshl_b32 s70, s71, 3
    s_add_u32 s69, s69, s70
    s_sub_u32 s69, s69, 16
    s_mul_i32 s69, s69, 896
    v_lshrrev_b32 v15, 3, v1
    v_mul_u32_u24 v17, 896, v15
    v_add_u32 v17, s69, v17
    v_lshrrev_b32 v16, 4, v1
    v_xor_b32 v16, v16, v1
    s_lshl_b32 s70, s71, 2
    v_xor_b32 v16, s70, v16
    v_and_b32 v16, 7, v16
    v_lshl_add_u32 v5, v16, 4, v17
    s_mul_i32 s77, s68, 112
    s_nop 0
    s_mov_b32 s32, s6
    s_mov_b32 s33, s7
    s_mov_b32 s34, 1204224
    s_mov_b32 s35, 0x20000
    s_add_u32 m0, s73, 98304
    s_mul_i32 s89, s4, 1344
    s_add_u32 s89, s89, s77
    buffer_load_dwordx4 v4, s[32:35], s89 offen offset:0 lds
    s_add_u32 m0, s73, 105600
    s_nop 0
    buffer_load_dwordx4 v4, s[32:35], s89 offen offset:896 lds
    s_add_u32 m0, s73, 112896
    s_nop 0
    buffer_load_dwordx4 v4, s[32:35], s89 offen offset:1792 lds
    s_lshr_b32 s69, s64, 1
    s_lshl_b32 s69, s69, 7
    s_add_u32 s69, s69, s4
    s_sub_u32 s70, s69, 896
    s_cmp_ge_u32 s69, 896
    s_cselect_b32 s69, s70, s69
    s_add_u32 m0, s73, 122880
    s_nop 0
    buffer_load_dwordx4 v5, s[28:31], s69 offen lds
    s_cmp_lt_u32 s64, 6
    s_cselect_b32 s70, 512, 0
    s_cselect_b32 s71, 8192, 0
    s_add_u32 s69, s69, s70
    s_sub_u32 s70, s69, 896
    s_cmp_ge_u32 s69, 896
    s_cselect_b32 s69, s70, s69
    s_add_u32 s71, s71, s73
    s_add_u32 m0, s71, 122880
    s_nop 0
    buffer_load_dwordx4 v5, s[28:31], s69 offen lds
    s_add_u32 s5, s4, 128
    s_cmp_eq_u32 s5, 896
    s_cselect_b32 s5, 0, s5
    s_add_u32 s6, s5, 128
    s_cmp_eq_u32 s6, 896
    s_cselect_b32 s6, 0, s6
    s_add_u32 s7, s6, 128
    s_cmp_eq_u32 s7, 896
    s_cselect_b32 s7, 0, s7
    s_add_u32 s10, s7, 128
    s_cmp_eq_u32 s10, 896
    s_cselect_b32 s10, 0, s10
    s_add_u32 s11, s10, 128
    s_cmp_eq_u32 s11, 896
    s_cselect_b32 s11, 0, s11
    s_add_u32 s12, s11, 128
    s_cmp_eq_u32 s12, 896
    s_cselect_b32 s12, 0, s12
    s_barrier
    s_mov_b32 s36, s24
    s_mov_b32 s37, s25
    s_mov_b32 s38, 9699328
    s_mov_b32 s39, 0x20000
    s_mov_b32 s60, s22
    s_mov_b32 s61, s23
    s_mov_b32 s62, 256
    s_mov_b32 s63, 0x20000
    s_xor_b32 s71, s75, s74
    v_and_b32 v15, 31, v1
    s_lshl_b32 s69, s74, 5
    v_add_u32 v15, s69, v15
    v_bfe_u32 v16, v1, 1, 3
    v_lshrrev_b32 v17, 5, v1
    v_xor_b32 v16, v16, v17
    v_lshlrev_b32 v16, 4, v16
    v_lshl_add_u32 v16, v15, 7, v16
    s_lshl_b32 s69, s71, 5
    v_xor_b32 v6, s69, v16
    v_xor_b32 v7, 32, v6
    v_xor_b32 v8, 64, v6
    v_xor_b32 v9, 0x60, v6
    v_lshlrev_b32 v17, 3, v17
    v_bfe_u32 v16, v1, 2, 2
    v_add_u32 v17, v17, v16
    v_lshlrev_b32 v17, 7, v17
    v_and_b32 v16, 16, v1
    v_lshlrev_b32 v16, 1, v16
    v_and_b32 v18, 3, v1
    v_lshl_add_u32 v16, v18, 3, v16
    s_mul_i32 s69, s75, 56
    v_add_u32 v16, s69, v16
    v_and_b32 v18, 8, v1
    v_lshlrev_b32 v18, 3, v18
    v_xor_b32 v16, v16, v18
    v_add_u32 v17, v17, v16
    s_lshl_b32 s69, s71, 11
    v_xor_b32 v10, s69, v17
    v_xor_b32 v11, 0x800, v10
    v_xor_b32 v12, 0x1000, v10
    v_xor_b32 v13, 0x1800, v10
    v_mov_b32 v240, v15
    v_and_b32 v241, 15, v1
    v_lshrrev_b32 v242, 4, v1
    v_lshrrev_b32 v15, 1, v241
    v_lshrrev_b32 v16, 5, v1
    v_xor_b32 v15, v15, v16
    s_xor_b32 s69, s71, 1
    s_lshl_b32 s69, s69, 1
    v_xor_b32 v15, s69, v15
    v_lshlrev_b32 v15, 4, v15
    v_lshl_add_u32 v15, v241, 7, v15
    v_add_u32 v14, 122880, v15
    v_and_b32 v129, 1, v242
    v_add_u32 v128, -1, v129
    v_not_b32 v129, v128
    v_add_u32 v10, 98304, v10
    v_add_u32 v6, 81920, v6
    v_add_u32 v11, 98304, v11
    v_add_u32 v7, 81920, v7
    v_add_u32 v12, 98304, v12
    v_add_u32 v8, 81920, v8
    v_add_u32 v13, 98304, v13
    v_add_u32 v9, 81920, v9
    v_lshrrev_b32 v15, 2, v1
    v_lshrrev_b32 v16, 4, v1
    v_xor_b32 v15, v15, v16
    v_and_b32 v15, 1, v15
    v_add_u32 v15, -1, v15
    v_and_b32 v100, 0x3f803f80, v15
    v_mov_b32 v101, v100
    v_mov_b32 v102, v100
    v_mov_b32 v103, v100
    v_mov_b32 v104, 0x3f803f80
    v_mov_b32 v105, 0x3f803f80
    v_mov_b32 v106, 0x3f803f80
    v_mov_b32 v107, 0x3f803f80
    v_mov_b32 v88, 0
    v_mov_b32 v89, 0
    v_mov_b32 v92, 0
    v_mov_b32 v93, 0
    v_mov_b32 v96, 0
    v_mov_b32 v97, 0
    v_lshlrev_b32 v15, 2, v242
    v_sub_u32 v15, v241, v15
    v_mov_b32 v18, 0xf149f2ca
    v_subrev_u32 v16, 0, v15
    v_and_b32 v17, 0xfffffff1, v16
    v_cmp_eq_u32 vcc, 0, v17
    s_nop 1
    v_cndmask_b32 v112, v18, 0, vcc
    v_add_u32 v16, 16, v16
    v_and_b32 v17, 0xfffffff1, v16
    v_cmp_eq_u32 vcc, 0, v17
    s_nop 1
    v_cndmask_b32 v108, v18, 0, vcc
    v_subrev_u32 v16, 1, v15
    v_and_b32 v17, 0xfffffff1, v16
    v_cmp_eq_u32 vcc, 0, v17
    s_nop 1
    v_cndmask_b32 v113, v18, 0, vcc
    v_add_u32 v16, 16, v16
    v_and_b32 v17, 0xfffffff1, v16
    v_cmp_eq_u32 vcc, 0, v17
    s_nop 1
    v_cndmask_b32 v109, v18, 0, vcc
    v_subrev_u32 v16, 2, v15
    v_and_b32 v17, 0xfffffff1, v16
    v_cmp_eq_u32 vcc, 0, v17
    s_nop 1
    v_cndmask_b32 v114, v18, 0, vcc
    v_add_u32 v16, 16, v16
    v_and_b32 v17, 0xfffffff1, v16
    v_cmp_eq_u32 vcc, 0, v17
    s_nop 1
    v_cndmask_b32 v110, v18, 0, vcc
    v_subrev_u32 v16, 3, v15
    v_and_b32 v17, 0xfffffff1, v16
    v_cmp_eq_u32 vcc, 0, v17
    s_nop 1
    v_cndmask_b32 v115, v18, 0, vcc
    v_add_u32 v16, 16, v16
    v_and_b32 v17, 0xfffffff1, v16
    v_cmp_eq_u32 vcc, 0, v17
    s_nop 1
    v_cndmask_b32 v111, v18, 0, vcc
    s_or_b32 s69, s67, s74
    s_cmp_eq_u32 s69, 0
    s_cselect_b64 vcc, -1, 0
    v_cndmask_b32 v116, v108, v18, vcc
    v_cndmask_b32 v117, v109, v18, vcc
    v_cndmask_b32 v118, v110, v18, vcc
    v_cndmask_b32 v119, v111, v18, vcc
    s_lshl_b32 s69, s67, 2
    s_add_u32 s69, s69, s74
    s_lshl_b32 s69, s69, 15
    s_lshl_b32 s70, s68, 1
    s_add_u32 s70, s70, s75
    s_lshl_b32 s70, s70, 11
    s_add_u32 s76, s69, s70
    s_add_u32 s76, s76, 7340032
    s_and_b32 s78, s66, 15
    s_lshl_b32 s78, s78, 3
    s_add_u32 s78, s78, s64
    s_mul_i32 s78, s78, 4
    v_lshlrev_b32 v23, 7, v1
    s_mul_i32 s69, s75, 1536
    s_add_u32 s69, s69, 122880
    v_and_b32 v15, 31, v1
    v_lshlrev_b32 v243, 4, v15
    v_add_u32 v243, s69, v243
    s_lshl_b32 s70, s74, 2
    v_add_u32 v239, s70, v243
    v_lshlrev_b32 v16, 4, v1
    s_lshl_b32 s69, s75, 14
    s_add_u32 s69, s69, 131072
    s_lshl_b32 s70, s74, 10
    s_add_u32 s70, s70, s69
    v_add_u32 v244, s70, v16
    s_lshl_b32 s70, s74, 12
    s_add_u32 s70, s70, s69
    v_add_u32 v245, s70, v16
    s_lshl_b32 s69, s74, 7
    v_lshrrev_b32 v247, 5, v1
    v_add_u32 v22, -1, v247
    v_lshlrev_b32 v247, 4, v247
    v_add_u32 v247, s69, v247
    s_lshl_b32 s69, s75, 13
    s_add_u32 s69, s69, 131072
    s_lshr_b32 s70, s74, 1
    s_lshl_b32 s70, s70, 10
    s_and_b32 s71, s74, 1
    s_lshl_b32 s71, s71, 3
    s_add_u32 s70, s70, s71
    s_add_u32 s70, s70, s69
    v_add_u32 v20, s70, v16
    s_lshl_b32 s70, s74, 11
    s_add_u32 s69, s69, s70
    v_add_u32 v19, s69, v16
    s_add_u32 s69, s69, 2048
    s_cmp_eq_u32 s74, 3
    s_cselect_b32 s69, 147456, s69
    v_add_u32 v135, s69, v16
    v_lshlrev_b32 v21, 9, v242
    v_lshl_add_u32 v21, v241, 4, v21
    s_and_b32 s69, s74, 1
    s_sub_u32 s69, 0, s69
    v_xor_b32 v251, s69, v128
    v_and_b32 v251, v251, v22
    s_lshr_b32 s71, s64, 1
    s_and_b32 s70, s64, 1
    v_lshrrev_b32 v15, 3, v1
    s_lshl_b32 s69, s70, 3
    v_add_u32 v15, s69, v15
    v_mul_u32_u24 v15, 896, v15
    v_lshrrev_b32 v16, 2, v1
    v_and_b32 v16, 4, v16
    v_xor_b32 v16, v16, v1
    v_and_b32 v16, 7, v16
    v_lshl_add_u32 v249, v16, 4, v15
    s_lshl_b32 s69, s91, 7
    v_add_u32 v249, s69, v249
    s_lshl_b32 s69, s71, 14
    s_lshl_b32 s70, s70, 10
    s_add_u32 s98, s69, s70
    s_mul_i32 s99, s71, 401408
    s_and_b32 s69, s90, 3
    s_lshl_b32 s69, s69, 1
    s_and_b32 s70, s65, 1
    s_add_u32 s69, s69, s70
    s_lshl_b32 s69, s69, 11
    s_add_u32 s0, s69, 0
    s_and_b32 s0, s0, 0x3fff
    s_and_b32 s70, s0, 0x2000
    s_mul_i32 s70, s70, 3
    s_add_u32 s70, s70, s0
    s_mul_i32 s70, s70, 7
    s_add_u32 s80, s70, s99
    s_add_u32 s1, s69, 2048
    s_and_b32 s1, s1, 0x3fff
    s_and_b32 s70, s1, 0x2000
    s_mul_i32 s70, s70, 3
    s_add_u32 s70, s70, s1
    s_mul_i32 s70, s70, 7
    s_add_u32 s81, s70, s99
    s_add_u32 s3, s69, 4096
    s_and_b32 s3, s3, 0x3fff
    s_and_b32 s70, s3, 0x2000
    s_mul_i32 s70, s70, 3
    s_add_u32 s70, s70, s3
    s_mul_i32 s70, s70, 7
    s_add_u32 s82, s70, s99
    s_add_u32 s13, s69, 6144
    s_and_b32 s13, s13, 0x3fff
    s_and_b32 s70, s13, 0x2000
    s_mul_i32 s70, s70, 3
    s_add_u32 s70, s70, s13
    s_mul_i32 s70, s70, 7
    s_add_u32 s83, s70, s99
    s_add_u32 s14, s69, 8192
    s_and_b32 s14, s14, 0x3fff
    s_and_b32 s70, s14, 0x2000
    s_mul_i32 s70, s70, 3
    s_add_u32 s70, s70, s14
    s_mul_i32 s70, s70, 7
    s_add_u32 s84, s70, s99
    s_add_u32 s15, s69, 10240
    s_and_b32 s15, s15, 0x3fff
    s_and_b32 s70, s15, 0x2000
    s_mul_i32 s70, s70, 3
    s_add_u32 s70, s70, s15
    s_mul_i32 s70, s70, 7
    s_add_u32 s85, s70, s99
    s_add_u32 s22, s69, 12288
    s_and_b32 s22, s22, 0x3fff
    s_and_b32 s70, s22, 0x2000
    s_mul_i32 s70, s70, 3
    s_add_u32 s70, s70, s22
    s_mul_i32 s70, s70, 7
    s_add_u32 s86, s70, s99
    s_add_u32 s23, s69, 14336
    s_and_b32 s23, s23, 0x3fff
    s_and_b32 s70, s23, 0x2000
    s_mul_i32 s70, s70, 3
    s_add_u32 s70, s70, s23
    s_mul_i32 s70, s70, 7
    s_add_u32 s87, s70, s99
    v_subrev_u32 v5, 48, v1
    v_ashrrev_i32 v5, 31, v5
    s_add_u32 m0, s72, 0
    s_nop 0
    buffer_load_dwordx4 v2, s[28:31], s5 offen lds
    s_add_u32 m0, s72, 1024
    s_nop 0
    buffer_load_dwordx4 v3, s[28:31], s5 offen lds
    s_add_u32 m0, s73, 16384
    s_mul_i32 s89, s5, 1344
    s_add_u32 s89, s89, s77
    buffer_load_dwordx4 v4, s[32:35], s89 offen offset:0 lds
    s_add_u32 m0, s73, 23680
    s_nop 0
    buffer_load_dwordx4 v4, s[32:35], s89 offen offset:896 lds
    s_add_u32 m0, s73, 30976
    s_nop 0
    buffer_load_dwordx4 v4, s[32:35], s89 offen offset:1792 lds
    s_branch L_att_body
L_mlp_body:
    s_waitcnt vmcnt(7)
    s_barrier
    ds_read_b128 v[24:27], v18 offset:0
    ds_read_b128 v[28:31], v19 offset:0
    ds_read_b64_tr_b16 v[168:169], v10 offset:49152
    ds_read_b64_tr_b16 v[170:171], v10 offset:49664
    ds_read_b64_tr_b16 v[172:173], v11 offset:49152
    ds_read_b64_tr_b16 v[174:175], v11 offset:49664
    ds_read_b64_tr_b16 v[176:177], v12 offset:49152
    ds_read_b64_tr_b16 v[178:179], v12 offset:49664
    ds_read_b128 v[32:35], v20 offset:0
    ds_read_b128 v[36:39], v21 offset:0
    ds_read_b64_tr_b16 v[180:181], v13 offset:49152
    ds_read_b64_tr_b16 v[182:183], v13 offset:49664
    s_waitcnt lgkmcnt(8)
    v_dot2c_f32_bf16 v218, v24, v24
    v_dot2c_f32_bf16 v219, v25, v25
    v_dot2c_f32_bf16 v218, v26, v26
    v_dot2c_f32_bf16 v219, v27, v27
    v_mfma_f32_32x32x16_bf16 v[136:151], v[168:171], v[24:27], 0
    s_add_u32 m0, s72, 32768
    s_nop 0
    buffer_load_dwordx4 v2, s[28:31], s6 offen lds
    s_add_u32 m0, s72, 33792
    s_nop 0
    buffer_load_dwordx4 v3, s[28:31], s6 offen lds
    v_mfma_f32_16x16x32_bf16 v[192:195], v[196:199], v[168:171], 0
    s_waitcnt vmcnt(6)
    s_barrier
    s_or_b32 s69, s2, s64
    s_cmp_eq_u32 s69, 0
    s_cbranch_scc0 L_noflaga
    v_mov_b32 v236, 0
    v_mov_b32 v237, 1
    buffer_store_dword v237, v236, s[60:63], 0 offen sc1
L_noflaga:
    ds_read_b64_tr_b16 v[184:185], v10 offset:57344
    ds_read_b64_tr_b16 v[186:187], v10 offset:57856
    s_waitcnt lgkmcnt(8)
    v_mfma_f32_32x32x16_bf16 v[136:151], v[172:175], v[28:31], v[136:151]
    ds_read_b128 v[40:43], v18 offset:16384
    ds_read_b128 v[44:47], v19 offset:16384
    s_add_u32 m0, s73, 131072
    s_nop 0
    buffer_load_dwordx4 v4, s[32:35], s54 offen offset:0 lds
    s_add_u32 m0, s72, 49152
    s_nop 0
    buffer_load_dwordx4 v2, s[28:31], s7 offen lds
    v_mfma_f32_16x16x32_bf16 v[220:223], v[196:199], v[24:27], 0
    ds_read_b64_tr_b16 v[188:189], v11 offset:57344
    ds_read_b64_tr_b16 v[190:191], v11 offset:57856
    s_waitcnt lgkmcnt(9)
    v_dot2c_f32_bf16 v218, v32, v32
    v_dot2c_f32_bf16 v219, v33, v33
    v_dot2c_f32_bf16 v218, v34, v34
    v_dot2c_f32_bf16 v219, v35, v35
    v_mfma_f32_32x32x16_bf16 v[136:151], v[176:179], v[32:35], v[136:151]
    ds_read_b128 v[48:51], v20 offset:16384
    ds_read_b128 v[52:55], v21 offset:16384
    s_add_u32 m0, s72, 50176
    s_nop 0
    buffer_load_dwordx4 v3, s[28:31], s7 offen lds
    s_add_u32 m0, s73, 139264
    s_nop 0
    buffer_load_dwordx4 v4, s[32:35], s55 offen offset:0 lds
    ds_read_b64_tr_b16 v[168:169], v12 offset:57344
    ds_read_b64_tr_b16 v[170:171], v12 offset:57856
    s_waitcnt lgkmcnt(10)
    v_mfma_f32_32x32x16_bf16 v[136:151], v[180:183], v[36:39], v[136:151]
    s_add_u32 m0, s72, 65536
    s_nop 0
    buffer_load_dwordx4 v2, s[28:31], s10 offen lds
    s_add_u32 m0, s72, 66560
    s_nop 0
    buffer_load_dwordx4 v3, s[28:31], s10 offen lds
    v_mfma_f32_16x16x32_bf16 v[220:223], v[196:199], v[32:35], v[220:223]
    ds_read_b64_tr_b16 v[172:173], v13 offset:57344
    ds_read_b64_tr_b16 v[174:175], v13 offset:57856
    s_waitcnt lgkmcnt(9)
    v_dot2c_f32_bf16 v218, v40, v40
    v_dot2c_f32_bf16 v219, v41, v41
    v_dot2c_f32_bf16 v218, v42, v42
    v_dot2c_f32_bf16 v219, v43, v43
    v_mfma_f32_32x32x16_bf16 v[136:151], v[184:187], v[40:43], v[136:151]
    s_add_u32 m0, s73, 147456
    s_nop 0
    buffer_load_dwordx4 v4, s[32:35], s56 offen offset:0 lds
    s_add_u32 m0, s72, 81920
    s_nop 0
    buffer_load_dwordx4 v2, s[28:31], s11 offen lds
    v_mfma_f32_16x16x32_bf16 v[192:195], v[196:199], v[184:187], v[192:195]
    s_waitcnt vmcnt(7)
    s_barrier
    ds_read_b64_tr_b16 v[176:177], v14 offset:0
    ds_read_b64_tr_b16 v[178:179], v14 offset:512
    s_waitcnt lgkmcnt(8)
    v_mfma_f32_32x32x16_bf16 v[136:151], v[188:191], v[44:47], v[136:151]
    ds_read_b128 v[56:59], v18 offset:32768
    ds_read_b128 v[60:63], v19 offset:32768
    s_add_u32 m0, s72, 82944
    s_nop 0
    buffer_load_dwordx4 v3, s[28:31], s11 offen lds
    s_add_u32 m0, s72, 98304
    s_nop 0
    buffer_load_dwordx4 v2, s[28:31], s12 offen lds
    v_mfma_f32_16x16x32_bf16 v[220:223], v[196:199], v[40:43], v[220:223]
    ds_read_b64_tr_b16 v[180:181], v15 offset:0
    ds_read_b64_tr_b16 v[182:183], v15 offset:512
    s_waitcnt lgkmcnt(8)
    v_dot2c_f32_bf16 v218, v48, v48
    v_dot2c_f32_bf16 v219, v49, v49
    v_dot2c_f32_bf16 v218, v50, v50
    v_dot2c_f32_bf16 v219, v51, v51
    v_mfma_f32_32x32x16_bf16 v[136:151], v[168:171], v[48:51], v[136:151]
    ds_read_b128 v[64:67], v20 offset:32768
    ds_read_b128 v[68:71], v21 offset:32768
    s_add_u32 m0, s72, 99328
    s_nop 0
    buffer_load_dwordx4 v3, s[28:31], s12 offen lds
    ds_read_b64_tr_b16 v[184:185], v16 offset:0
    ds_read_b64_tr_b16 v[186:187], v16 offset:512
    s_waitcnt lgkmcnt(10)
    v_mfma_f32_32x32x16_bf16 v[136:151], v[172:175], v[52:55], v[136:151]
    v_mfma_f32_16x16x32_bf16 v[220:223], v[196:199], v[48:51], v[220:223]
    ds_read_b64_tr_b16 v[188:189], v17 offset:0
    ds_read_b64_tr_b16 v[190:191], v17 offset:512
    s_waitcnt lgkmcnt(9)
    v_dot2c_f32_bf16 v218, v56, v56
    v_dot2c_f32_bf16 v219, v57, v57
    v_dot2c_f32_bf16 v218, v58, v58
    v_dot2c_f32_bf16 v219, v59, v59
    v_mfma_f32_32x32x16_bf16 v[136:151], v[176:179], v[56:59], v[136:151]
    v_mfma_f32_16x16x32_bf16 v[192:195], v[196:199], v[176:179], v[192:195]
    s_waitcnt vmcnt(4)
    s_waitcnt lgkmcnt(4)
    s_barrier
    s_add_u32 m0, s73, 0
    s_nop 0
    buffer_load_dwordx4 v4, s[32:35], s57 offen offset:0 lds
    s_add_u32 m0, s73, 8192
    s_nop 0
    buffer_load_dwordx4 v4, s[32:35], s58 offen offset:0 lds
    s_add_u32 m0, s73, 16256
    s_nop 0
    buffer_load_dwordx4 v4, s[32:35], s52 offen offset:128 lds
    s_cmp_eq_u32 s64, 4
    s_cbranch_scc0 L_svc1
    v_mov_b32 v253, 0
    buffer_load_dword v253, off, s[60:63], 0 sc1
L_svc1:
    ds_read_b64_tr_b16 v[168:169], v14 offset:8192
    ds_read_b64_tr_b16 v[170:171], v14 offset:8704
    v_mfma_f32_32x32x16_bf16 v[136:151], v[180:183], v[60:63], v[136:151]
    ds_read_b128 v[72:75], v18 offset:49152
    ds_read_b128 v[76:79], v19 offset:49152
    v_mfma_f32_16x16x32_bf16 v[220:223], v[196:199], v[56:59], v[220:223]
    s_cmp_eq_u32 s27, 0
    s_cbranch_scc0 L_site2
    s_add_u32 m0, s73, 24448
    s_nop 0
    buffer_load_dwordx4 v4, s[32:35], s53 offen offset:128 lds
    s_add_u32 m0, s73, 32640
    s_nop 0
    buffer_load_dwordx4 v4, s[32:35], s54 offen offset:128 lds
    s_add_u32 m0, s73, 40832
    s_nop 0
    buffer_load_dwordx4 v4, s[32:35], s55 offen offset:128 lds
L_site2:
    ds_read_b64_tr_b16 v[172:173], v15 offset:8192
    ds_read_b64_tr_b16 v[174:175], v15 offset:8704
    s_waitcnt lgkmcnt(8)
    v_dot2c_f32_bf16 v218, v64, v64
    v_dot2c_f32_bf16 v219, v65, v65
    v_dot2c_f32_bf16 v218, v66, v66
    v_dot2c_f32_bf16 v219, v67, v67
    v_mfma_f32_32x32x16_bf16 v[136:151], v[184:187], v[64:67], v[136:151]
    ds_read_b128 v[80:83], v20 offset:49152
    ds_read_b128 v[84:87], v21 offset:49152
    ds_read_b64_tr_b16 v[176:177], v16 offset:8192
    ds_read_b64_tr_b16 v[178:179], v16 offset:8704
    s_waitcnt lgkmcnt(10)
    v_mfma_f32_32x32x16_bf16 v[136:151], v[188:191], v[68:71], v[136:151]
    v_add_u32 v18, 0x10000, v18
    v_add_u32 v19, 0x10000, v19
    v_add_u32 v20, 0x10000, v20
    v_add_u32 v21, 0x10000, v21
    ds_read_b128 v[88:91], v18 offset:0
    ds_read_b128 v[92:95], v19 offset:0
    v_mfma_f32_16x16x32_bf16 v[220:223], v[196:199], v[64:67], v[220:223]
    ds_read_b64_tr_b16 v[180:181], v17 offset:8192
    ds_read_b64_tr_b16 v[182:183], v17 offset:8704
    s_waitcnt lgkmcnt(11)
    v_dot2c_f32_bf16 v218, v72, v72
    v_dot2c_f32_bf16 v219, v73, v73
    v_dot2c_f32_bf16 v218, v74, v74
    v_dot2c_f32_bf16 v219, v75, v75
    v_mfma_f32_32x32x16_bf16 v[136:151], v[168:171], v[72:75], v[136:151]
    ds_read_b128 v[96:99], v20 offset:0
    ds_read_b128 v[100:103], v21 offset:0
    v_mfma_f32_16x16x32_bf16 v[192:195], v[196:199], v[168:171], v[192:195]
    s_cmp_eq_u32 s27, 1
    s_cbranch_scc0 L_site3
    s_add_u32 m0, s73, 24448
    s_nop 0
    buffer_load_dwordx4 v4, s[32:35], s53 offen offset:128 lds
    s_add_u32 m0, s73, 32640
    s_nop 0
    buffer_load_dwordx4 v4, s[32:35], s54 offen offset:128 lds
    s_add_u32 m0, s73, 40832
    s_nop 0
    buffer_load_dwordx4 v4, s[32:35], s55 offen offset:128 lds
L_site3:
    ds_read_b64_tr_b16 v[184:185], v14 offset:16384
    ds_read_b64_tr_b16 v[186:187], v14 offset:16896
    s_waitcnt lgkmcnt(12)
    v_mfma_f32_32x32x16_bf16 v[136:151], v[172:175], v[76:79], v[136:151]
    v_mfma_f32_16x16x32_bf16 v[220:223], v[196:199], v[72:75], v[220:223]
    ds_read_b64_tr_b16 v[188:189], v15 offset:16384
    ds_read_b64_tr_b16 v[190:191], v15 offset:16896
    s_waitcnt lgkmcnt(10)
    v_dot2c_f32_bf16 v218, v80, v80
    v_dot2c_f32_bf16 v219, v81, v81
    v_dot2c_f32_bf16 v218, v82, v82
    v_dot2c_f32_bf16 v219, v83, v83
    v_mfma_f32_32x32x16_bf16 v[136:151], v[176:179], v[80:83], v[136:151]
    ds_read_b64_tr_b16 v[168:169], v16 offset:16384
    ds_read_b64_tr_b16 v[170:171], v16 offset:16896
    s_waitcnt lgkmcnt(8)
    v_mfma_f32_32x32x16_bf16 v[136:151], v[180:183], v[84:87], v[136:151]
    v_mfma_f32_16x16x32_bf16 v[220:223], v[196:199], v[80:83], v[220:223]
    ds_read_b64_tr_b16 v[172:173], v17 offset:16384
    ds_read_b64_tr_b16 v[174:175], v17 offset:16896
    s_waitcnt lgkmcnt(6)
    v_dot2c_f32_bf16 v218, v88, v88
    v_dot2c_f32_bf16 v219, v89, v89
    v_dot2c_f32_bf16 v218, v90, v90
    v_dot2c_f32_bf16 v219, v91, v91
    v_mfma_f32_32x32x16_bf16 v[136:151], v[184:187], v[88:91], v[136:151]
    v_mfma_f32_16x16x32_bf16 v[192:195], v[196:199], v[184:187], v[192:195]
    s_waitcnt vmcnt(3)
    s_barrier
    s_cmp_eq_u32 s27, 0
    s_cbranch_scc0 L_site4
    s_add_u32 m0, s73, 49024
    s_nop 0
    buffer_load_dwordx4 v4, s[32:35], s56 offen offset:128 lds
    s_add_u32 m0, s73, 57216
    s_nop 0
    buffer_load_dwordx4 v4, s[32:35], s57 offen offset:128 lds
    s_add_u32 m0, s73, 65408
    s_nop 0
    buffer_load_dwordx4 v4, s[32:35], s58 offen offset:128 lds
    s_add_u32 m0, s73, 73472
    s_nop 0
    buffer_load_dwordx4 v4, s[32:35], s52 offen offset:256 lds
L_site4:
    ds_read_b64_tr_b16 v[176:177], v6 offset:0
    ds_read_b64_tr_b16 v[178:179], v6 offset:512
    s_waitcnt lgkmcnt(6)
    v_mfma_f32_32x32x16_bf16 v[136:151], v[188:191], v[92:95], v[136:151]
    ds_read_b128 v[104:107], v18 offset:16384
    ds_read_b128 v[108:111], v19 offset:16384
    v_mfma_f32_16x16x32_bf16 v[220:223], v[196:199], v[88:91], v[220:223]
    ds_read_b64_tr_b16 v[180:181], v7 offset:0
    ds_read_b64_tr_b16 v[182:183], v7 offset:512
    s_waitcnt lgkmcnt(8)
    v_dot2c_f32_bf16 v218, v96, v96
    v_dot2c_f32_bf16 v219, v97, v97
    v_dot2c_f32_bf16 v218, v98, v98
    v_dot2c_f32_bf16 v219, v99, v99
    v_mfma_f32_32x32x16_bf16 v[136:151], v[168:171], v[96:99], v[136:151]
    ds_read_b128 v[112:115], v20 offset:16384
    ds_read_b128 v[116:119], v21 offset:16384
    ds_read_b64_tr_b16 v[184:185], v8 offset:0
    ds_read_b64_tr_b16 v[186:187], v8 offset:512
    s_waitcnt lgkmcnt(10)
    v_mfma_f32_32x32x16_bf16 v[136:151], v[172:175], v[100:103], v[136:151]
    ds_read_b128 v[120:123], v18 offset:32768
    ds_read_b128 v[124:127], v19 offset:32768
    v_mfma_f32_16x16x32_bf16 v[220:223], v[196:199], v[96:99], v[220:223]
    s_cmp_eq_u32 s27, 1
    s_cbranch_scc0 L_site5
    s_add_u32 m0, s73, 49024
    s_nop 0
    buffer_load_dwordx4 v4, s[32:35], s56 offen offset:128 lds
    s_add_u32 m0, s73, 57216
    s_nop 0
    buffer_load_dwordx4 v4, s[32:35], s57 offen offset:128 lds
    s_add_u32 m0, s73, 65408
    s_nop 0
    buffer_load_dwordx4 v4, s[32:35], s58 offen offset:128 lds
    s_add_u32 m0, s73, 73472
    s_nop 0
    buffer_load_dwordx4 v4, s[32:35], s52 offen offset:256 lds
L_site5:
    ds_read_b64_tr_b16 v[188:189], v9 offset:0
    ds_read_b64_tr_b16 v[190:191], v9 offset:512
    s_waitcnt lgkmcnt(11)
    v_dot2c_f32_bf16 v218, v104, v104
    v_dot2c_f32_bf16 v219, v105, v105
    v_dot2c_f32_bf16 v218, v106, v106
    v_dot2c_f32_bf16 v219, v107, v107
    v_mfma_f32_32x32x16_bf16 v[136:151], v[176:179], v[104:107], v[136:151]
    ds_read_b128 v[128:131], v20 offset:32768
    ds_read_b128 v[132:135], v21 offset:32768
    v_mfma_f32_16x16x32_bf16 v[192:195], v[196:199], v[176:179], v[192:195]
    ds_read_b64_tr_b16 v[168:169], v6 offset:8192
    ds_read_b64_tr_b16 v[170:171], v6 offset:8704
    s_waitcnt lgkmcnt(12)
    v_mfma_f32_32x32x16_bf16 v[136:151], v[180:183], v[108:111], v[136:151]
    v_mfma_f32_16x16x32_bf16 v[220:223], v[196:199], v[104:107], v[220:223]
    s_lshl_b32 s69, s2, 3
    s_add_u32 s69, s69, s64
    s_lshl_b32 s70, s69, 10
    s_mov_b32 s48, s16
    s_mov_b32 s49, s17
    s_mov_b32 s50, 1605632
    s_mov_b32 s51, 0x20000
    s_cmp_lt_u32 s69, 1568
    s_cbranch_scc1 L_pf6
    s_mov_b32 s48, s8
    s_mov_b32 s49, s9
    s_mov_b32 s50, 401408
    s_sub_u32 s70, s70, 1605632
L_pf6:
    s_mov_b64 exec, 0xff
    buffer_load_dword v250, v244, s[48:51], s70 offen
    s_mov_b64 exec, -1
    ds_read_b64_tr_b16 v[172:173], v7 offset:8192
    ds_read_b64_tr_b16 v[174:175], v7 offset:8704
    s_waitcnt lgkmcnt(10)
    v_dot2c_f32_bf16 v218, v112, v112
    v_dot2c_f32_bf16 v219, v113, v113
    v_dot2c_f32_bf16 v218, v114, v114
    v_dot2c_f32_bf16 v219, v115, v115
    v_mfma_f32_32x32x16_bf16 v[136:151], v[184:187], v[112:115], v[136:151]
    ds_read_b64_tr_b16 v[176:177], v8 offset:8192
    ds_read_b64_tr_b16 v[178:179], v8 offset:8704
    s_waitcnt lgkmcnt(8)
    v_mfma_f32_32x32x16_bf16 v[136:151], v[188:191], v[116:119], v[136:151]
    v_mfma_f32_16x16x32_bf16 v[220:223], v[196:199], v[112:115], v[220:223]
    ds_read_b64_tr_b16 v[180:181], v9 offset:8192
    ds_read_b64_tr_b16 v[182:183], v9 offset:8704
    s_waitcnt lgkmcnt(6)
    v_dot2c_f32_bf16 v218, v120, v120
    v_dot2c_f32_bf16 v219, v121, v121
    v_dot2c_f32_bf16 v218, v122, v122
    v_dot2c_f32_bf16 v219, v123, v123
    v_mfma_f32_32x32x16_bf16 v[136:151], v[168:171], v[120:123], v[136:151]
    v_mfma_f32_16x16x32_bf16 v[192:195], v[196:199], v[168:171], v[192:195]
    ds_read_b64_tr_b16 v[184:185], v6 offset:16384
    ds_read_b64_tr_b16 v[186:187], v6 offset:16896
    s_waitcnt lgkmcnt(6)
    v_mfma_f32_32x32x16_bf16 v[136:151], v[172:175], v[124:127], v[136:151]
    v_mfma_f32_16x16x32_bf16 v[220:223], v[196:199], v[120:123], v[220:223]
    ds_read_b64_tr_b16 v[188:189], v7 offset:16384
    ds_read_b64_tr_b16 v[190:191], v7 offset:16896
    s_waitcnt lgkmcnt(6)
    v_dot2c_f32_bf16 v218, v128, v128
    v_dot2c_f32_bf16 v219, v129, v129
    v_dot2c_f32_bf16 v218, v130, v130
    v_dot2c_f32_bf16 v219, v131, v131
    v_mfma_f32_32x32x16_bf16 v[136:151], v[176:179], v[128:131], v[136:151]
    ds_read_b64_tr_b16 v[168:169], v8 offset:16384
    ds_read_b64_tr_b16 v[170:171], v8 offset:16896
    s_waitcnt lgkmcnt(6)
    v_mfma_f32_32x32x16_bf16 v[136:151], v[180:183], v[132:135], v[136:151]
    v_mfma_f32_16x16x32_bf16 v[220:223], v[196:199], v[128:131], v[220:223]
    v_add_f32 v218, v218, v219
    v_mov_b32 v219, v218
    s_nop 1
    v_permlane32_swap_b32 v218, v219
    v_add_f32 v219, v218, v219
    s_nop 1
    v_mov_b32 v218, v220
    ds_write_b64 v216, v[218:219]
    ds_write_b32 v23, v192 offset:0
    ds_read_b64_tr_b16 v[172:173], v9 offset:16384
    ds_read_b64_tr_b16 v[174:175], v9 offset:16896
    s_waitcnt lgkmcnt(8)
    v_mfma_f32_32x32x16_bf16 v[152:167], v[184:187], v[24:27], 0
    v_mfma_f32_16x16x32_bf16 v[192:195], v[196:199], v[184:187], 0
    s_cmp_eq_u32 s64, 4
    s_cbranch_scc0 L_svc7
    v_cmp_gt_u32 vcc, 1, v253
    s_cbranch_vccz L_so8
    s_mov_b32 s71, 400000
    s_waitcnt vmcnt(0)
L_sl8:
    v_cmp_gt_u32 vcc, 1, v253
    s_cbranch_vccz L_so8
    buffer_load_dword v253, off, s[60:63], 0 sc1
    s_sub_u32 s71, s71, 1
    s_cbranch_scc1 L_sx8
    s_waitcnt vmcnt(0)
    s_branch L_sl8
L_sx8:
    s_waitcnt vmcnt(0)
L_so8:
L_svc7:
    s_waitcnt vmcnt(1)
    s_waitcnt lgkmcnt(2)
    s_barrier
    ds_read_b64 v[232:233], v217
    ds_read_b128 v[236:239], v215 offset:0
    ds_read_b64_tr_b16 v[176:177], v6 offset:24576
    ds_read_b64_tr_b16 v[178:179], v6 offset:25088
    v_mfma_f32_32x32x16_bf16 v[152:167], v[188:191], v[28:31], v[152:167]
    ds_read_b64_tr_b16 v[180:181], v7 offset:24576
    ds_read_b64_tr_b16 v[182:183], v7 offset:25088
    v_mfma_f32_32x32x16_bf16 v[152:167], v[168:171], v[32:35], v[152:167]
    ds_read_b64_tr_b16 v[184:185], v8 offset:24576
    ds_read_b64_tr_b16 v[186:187], v8 offset:25088
    s_waitcnt lgkmcnt(8)
    v_mfma_f32_32x32x16_bf16 v[152:167], v[172:175], v[36:39], v[152:167]
    s_waitcnt lgkmcnt(7)
    v_add_f32 v230, v218, v232
    v_add_f32 v231, v219, v233
    v_mul_f32 v230, 0x3b124925, v230
    v_mul_f32 v231, 0x3b124925, v231
    v_fma_f32 v231, -v230, v230, v231
    v_max_f32 v231, 0, v231
    v_add_f32 v224, 0x3727c5ac, v231
    ds_read_b64_tr_b16 v[188:189], v9 offset:24576
    ds_read_b64_tr_b16 v[190:191], v9 offset:25088
    s_waitcnt lgkmcnt(6)
    v_mfma_f32_32x32x16_bf16 v[152:167], v[176:179], v[40:43], v[152:167]
    v_rsq_f32 v220, v224
    s_cmp_eq_u32 s27, 0
    s_cbranch_scc0 L_ss9
    s_lshl_b32 s69, s68, 14
    s_lshl_b32 s71, s67, 9
    s_add_u32 s69, s69, s71
    s_add_u32 s69, s69, 9502720
    v_subrev_u32 v221, 161792, v216
    v_lshrrev_b32 v221, 1, v221
    s_add_u32 s71, s69, 8192
    buffer_store_dword v220, v221, s[36:39], s69 offen sc1
    buffer_store_dword v230, v221, s[36:39], s71 offen sc1
L_ss9:
    v_cmp_gt_u32 vcc, 32, v1
    v_mul_f32 v226, v220, v220
    v_mul_f32 v226, v226, v231
    v_add_f32 v226, 0x3727c5ac, v226
    v_rsq_f32 v228, v226
    v_mfma_f32_16x16x32_bf16 v[192:195], v[196:199], v[176:179], v[192:195]
    v_mul_f32 v224, v224, v226
    v_sqrt_f32 v210, v224
    v_mul_f32 v228, v228, v220
    ds_read_b64_tr_b16 v[168:169], v6 offset:32768
    ds_read_b64_tr_b16 v[170:171], v6 offset:33280
    s_waitcnt lgkmcnt(6)
    v_mfma_f32_32x32x16_bf16 v[152:167], v[180:183], v[44:47], v[152:167]
    v_mul_f32 v208, 0xc0135761, v228
    v_mul_f32 v224, v228, v228
    v_mul_f32 v224, v224, v228
    v_mul_f32 v209, 0xbdd2d3e8, v224
    v_cndmask_b32 v224, 0, v230, vcc
    v_cndmask_b32 v225, 0, v210, vcc
    v_sub_f32 v224, 0, v224
    v_cvt_pk_bf16_f32 v201, v224, v225
    ds_read_b64_tr_b16 v[172:173], v7 offset:32768
    ds_read_b64_tr_b16 v[174:175], v7 offset:33280
    s_waitcnt lgkmcnt(6)
    v_mfma_f32_32x32x16_bf16 v[152:167], v[184:187], v[48:51], v[152:167]
    v_lshlrev_b32 v226, 16, v201
    v_sub_f32 v226, v224, v226
    v_cvt_pk_bf16_f32 v200, v224, v226
    v_and_b32 v226, 0xffff0000, v201
    v_sub_f32 v226, v225, v226
    v_cvt_pk_bf16_f32 v202, v226, v203
    v_lshlrev_b32 v228, 16, v211
    ds_read_b64_tr_b16 v[176:177], v8 offset:32768
    ds_read_b64_tr_b16 v[178:179], v8 offset:33280
    s_waitcnt lgkmcnt(6)
    v_mfma_f32_32x32x16_bf16 v[152:167], v[188:191], v[52:55], v[152:167]
    v_mov_b32 v206, v211
    v_add_f32 v224, v236, v237
    v_add_f32 v226, v238, v239
    v_add_f32 v224, v224, v226
    v_cvt_pk_bf16_f32 v204, v224, v224
    v_lshlrev_b32 v225, 16, v204
    v_sub_f32 v225, v224, v225
    ds_read_b64_tr_b16 v[180:181], v9 offset:32768
    ds_read_b64_tr_b16 v[182:183], v9 offset:33280
    s_waitcnt lgkmcnt(6)
    v_mfma_f32_32x32x16_bf16 v[152:167], v[168:171], v[56:59], v[152:167]
    v_cvt_pk_bf16_f32 v205, v225, v228
    s_add_u32 s88, s76, 0
    s_nop 0
    v_mfma_f32_32x32x16_bf16 v[136:151], v[204:207], v[200:203], v[136:151]
    s_cmp_eq_u32 s27, 0
    s_cbranch_scc0 L_site10
    s_add_u32 m0, s73, 81664
    s_nop 0
    buffer_load_dwordx4 v4, s[32:35], s53 offen offset:256 lds
    s_add_u32 m0, s73, 89856
    s_nop 0
    buffer_load_dwordx4 v4, s[32:35], s54 offen offset:256 lds
    s_add_u32 m0, s73, 98048
    s_nop 0
    buffer_load_dwordx4 v4, s[32:35], s55 offen offset:256 lds
    s_add_u32 m0, s73, 106240
    s_nop 0
    buffer_load_dwordx4 v4, s[32:35], s56 offen offset:256 lds
    s_add_u32 m0, s73, 114432
    s_nop 0
    buffer_load_dwordx4 v4, s[32:35], s57 offen offset:256 lds
    s_add_u32 m0, s73, 122624
    s_nop 0
    buffer_load_dwordx4 v4, s[32:35], s58 offen offset:256 lds
    s_lshr_b64 exec, -1, 32
    s_add_u32 m0, s59, 131072
    s_nop 0
    buffer_load_dwordx4 v5, s[32:35], s52 offen lds
    s_add_u32 m0, s59, 135168
    s_nop 0
    buffer_load_dwordx4 v5, s[32:35], s53 offen lds
    s_add_u32 m0, s59, 139264
    s_nop 0
    buffer_load_dwordx4 v5, s[32:35], s54 offen lds
    s_add_u32 m0, s59, 143360
    s_nop 0
    buffer_load_dwordx4 v5, s[32:35], s55 offen lds
    s_add_u32 m0, s59, 147456
    s_nop 0
    buffer_load_dwordx4 v5, s[32:35], s56 offen lds
    s_add_u32 m0, s59, 151552
    s_nop 0
    buffer_load_dwordx4 v5, s[32:35], s57 offen lds
    s_add_u32 m0, s59, 155648
    s_nop 0
    buffer_load_dwordx4 v5, s[32:35], s58 offen lds
    s_mov_b64 exec, -1
L_site10:
    s_nop 9
    v_mul_f32 v228, v136, v136
    v_mul_f32 v229, v137, v137
    v_mul_f32 v230, v138, v138
    v_mfma_f32_16x16x32_bf16 v[192:195], v[196:199], v[168:171], v[192:195]
    v_mul_f32 v231, v139, v139
    v_mul_f32 v232, v140, v140
    v_mul_f32 v233, v141, v141
    v_mul_f32 v234, v142, v142
    ds_read_b64_tr_b16 v[184:185], v6 offset:40960
    ds_read_b64_tr_b16 v[186:187], v6 offset:41472
    s_waitcnt lgkmcnt(6)
    v_mfma_f32_32x32x16_bf16 v[152:167], v[172:175], v[60:63], v[152:167]
    v_mul_f32 v235, v143, v143
    v_fma_f32 v228, v228, v209, v208
    v_fma_f32 v229, v229, v209, v208
    v_fma_f32 v230, v230, v209, v208
    v_fma_f32 v231, v231, v209, v208
    v_fma_f32 v232, v232, v209, v208
    v_fma_f32 v233, v233, v209, v208
    v_fma_f32 v234, v234, v209, v208
    ds_read_b64_tr_b16 v[188:189], v7 offset:40960
    ds_read_b64_tr_b16 v[190:191], v7 offset:41472
    s_waitcnt lgkmcnt(6)
    v_mfma_f32_32x32x16_bf16 v[152:167], v[176:179], v[64:67], v[152:167]
    v_fma_f32 v235, v235, v209, v208
    v_mul_f32 v228, v136, v228
    v_mul_f32 v229, v137, v229
    v_mul_f32 v230, v138, v230
    v_mul_f32 v231, v139, v231
    v_mul_f32 v232, v140, v232
    v_mul_f32 v233, v141, v233
    v_mul_f32 v234, v142, v234
    ds_read_b64_tr_b16 v[168:169], v8 offset:40960
    ds_read_b64_tr_b16 v[170:171], v8 offset:41472
    s_waitcnt lgkmcnt(6)
    v_mfma_f32_32x32x16_bf16 v[152:167], v[180:183], v[68:71], v[152:167]
    v_mul_f32 v235, v143, v235
    v_exp_f32 v228, v228
    v_exp_f32 v229, v229
    v_exp_f32 v230, v230
    v_exp_f32 v231, v231
    ds_read_b64_tr_b16 v[172:173], v9 offset:40960
    ds_read_b64_tr_b16 v[174:175], v9 offset:41472
    s_waitcnt lgkmcnt(6)
    v_mfma_f32_32x32x16_bf16 v[152:167], v[184:187], v[72:75], v[152:167]
    v_exp_f32 v232, v232
    v_exp_f32 v233, v233
    v_exp_f32 v234, v234
    v_exp_f32 v235, v235
    v_mfma_f32_16x16x32_bf16 v[192:195], v[196:199], v[184:187], v[192:195]
    v_fma_f32 v228, v228, v210, v210
    v_fma_f32 v229, v229, v210, v210
    v_fma_f32 v230, v230, v210, v210
    v_fma_f32 v231, v231, v210, v210
    ds_read_b64_tr_b16 v[176:177], v6 offset:49152
    ds_read_b64_tr_b16 v[178:179], v6 offset:49664
    s_waitcnt lgkmcnt(6)
    v_mfma_f32_32x32x16_bf16 v[152:167], v[188:191], v[76:79], v[152:167]
    v_fma_f32 v232, v232, v210, v210
    v_fma_f32 v233, v233, v210, v210
    v_fma_f32 v234, v234, v210, v210
    v_fma_f32 v235, v235, v210, v210
    v_rcp_f32 v228, v228
    v_rcp_f32 v229, v229
    ds_read_b64_tr_b16 v[180:181], v7 offset:49152
    ds_read_b64_tr_b16 v[182:183], v7 offset:49664
    s_waitcnt lgkmcnt(6)
    v_mfma_f32_32x32x16_bf16 v[152:167], v[168:171], v[80:83], v[152:167]
    v_rcp_f32 v230, v230
    v_rcp_f32 v231, v231
    v_rcp_f32 v232, v232
    v_rcp_f32 v233, v233
    ds_read_b64_tr_b16 v[184:185], v8 offset:49152
    ds_read_b64_tr_b16 v[186:187], v8 offset:49664
    s_waitcnt lgkmcnt(6)
    v_mfma_f32_32x32x16_bf16 v[152:167], v[172:175], v[84:87], v[152:167]
    v_rcp_f32 v234, v234
    v_rcp_f32 v235, v235
    v_mul_f32 v228, v136, v228
    v_mul_f32 v229, v137, v229
    s_cmp_eq_u32 s27, 0
    s_cbranch_scc0 L_sw11
    s_waitcnt vmcnt(26)
    s_lshl_b32 s69, s68, 11
    s_lshl_b32 s71, s67, 7
    s_add_u32 s69, s69, s71
    s_add_u32 s69, s69, 9445376
    v_mov_b32 v253, 1
    s_mov_b64 exec, 1
    buffer_atomic_add v253, off, s[36:39], s69 sc1
    s_mov_b64 exec, -1
L_sw11:
    ds_read_b64_tr_b16 v[188:189], v9 offset:49152
    ds_read_b64_tr_b16 v[190:191], v9 offset:49664
    s_waitcnt lgkmcnt(6)
    v_mfma_f32_32x32x16_bf16 v[152:167], v[176:179], v[88:91], v[152:167]
    v_mul_f32 v230, v138, v230
    v_mul_f32 v231, v139, v231
    v_mul_f32 v232, v140, v232
    v_mul_f32 v233, v141, v233
    v_mul_f32 v234, v142, v234
    v_mul_f32 v235, v143, v235
    v_cvt_pk_bf16_f32 v236, v228, v229
    v_cvt_pk_bf16_f32 v237, v230, v231
    v_mfma_f32_16x16x32_bf16 v[192:195], v[196:199], v[176:179], v[192:195]
    v_cvt_pk_bf16_f32 v238, v232, v233
    v_cvt_pk_bf16_f32 v239, v234, v235
    buffer_store_dwordx4 v[236:239], v22, s[36:39], s88 offen offset:0 sc1
    s_cmp_eq_u32 s27, 1
    s_cbranch_scc0 L_site12
    s_add_u32 m0, s73, 81664
    s_nop 0
    buffer_load_dwordx4 v4, s[32:35], s53 offen offset:256 lds
    s_add_u32 m0, s73, 89856
    s_nop 0
    buffer_load_dwordx4 v4, s[32:35], s54 offen offset:256 lds
    s_add_u32 m0, s73, 98048
    s_nop 0
    buffer_load_dwordx4 v4, s[32:35], s55 offen offset:256 lds
    s_add_u32 m0, s73, 106240
    s_nop 0
    buffer_load_dwordx4 v4, s[32:35], s56 offen offset:256 lds
    s_add_u32 m0, s73, 114432
    s_nop 0
    buffer_load_dwordx4 v4, s[32:35], s57 offen offset:256 lds
    s_add_u32 m0, s73, 122624
    s_nop 0
    buffer_load_dwordx4 v4, s[32:35], s58 offen offset:256 lds
    s_lshr_b64 exec, -1, 32
    s_add_u32 m0, s59, 131072
    s_nop 0
    buffer_load_dwordx4 v5, s[32:35], s52 offen lds
    s_add_u32 m0, s59, 135168
    s_nop 0
    buffer_load_dwordx4 v5, s[32:35], s53 offen lds
    s_add_u32 m0, s59, 139264
    s_nop 0
    buffer_load_dwordx4 v5, s[32:35], s54 offen lds
    s_add_u32 m0, s59, 143360
    s_nop 0
    buffer_load_dwordx4 v5, s[32:35], s55 offen lds
    s_add_u32 m0, s59, 147456
    s_nop 0
    buffer_load_dwordx4 v5, s[32:35], s56 offen lds
    s_add_u32 m0, s59, 151552
    s_nop 0
    buffer_load_dwordx4 v5, s[32:35], s57 offen lds
    s_add_u32 m0, s59, 155648
    s_nop 0
    buffer_load_dwordx4 v5, s[32:35], s58 offen lds
    s_mov_b64 exec, -1
L_site12:
    ds_read_b64_tr_b16 v[168:169], v6 offset:57344
    ds_read_b64_tr_b16 v[170:171], v6 offset:57856
    s_waitcnt lgkmcnt(6)
    v_mfma_f32_32x32x16_bf16 v[152:167], v[180:183], v[92:95], v[152:167]
    v_mul_f32 v228, v144, v144
    v_mul_f32 v229, v145, v145
    v_mul_f32 v230, v146, v146
    v_mul_f32 v231, v147, v147
    v_mul_f32 v232, v148, v148
    v_mul_f32 v233, v149, v149
    v_mul_f32 v234, v150, v150
    ds_read_b64_tr_b16 v[172:173], v7 offset:57344
    ds_read_b64_tr_b16 v[174:175], v7 offset:57856
    s_waitcnt lgkmcnt(6)
    v_mfma_f32_32x32x16_bf16 v[152:167], v[184:187], v[96:99], v[152:167]
    v_mul_f32 v235, v151, v151
    v_fma_f32 v228, v228, v209, v208
    v_fma_f32 v229, v229, v209, v208
    v_fma_f32 v230, v230, v209, v208
    v_fma_f32 v231, v231, v209, v208
    v_fma_f32 v232, v232, v209, v208
    v_fma_f32 v233, v233, v209, v208
    ds_read_b64_tr_b16 v[176:177], v8 offset:57344
    ds_read_b64_tr_b16 v[178:179], v8 offset:57856
    s_waitcnt lgkmcnt(6)
    v_mfma_f32_32x32x16_bf16 v[152:167], v[188:191], v[100:103], v[152:167]
    v_fma_f32 v234, v234, v209, v208
    v_fma_f32 v235, v235, v209, v208
    v_mul_f32 v228, v144, v228
    v_mul_f32 v229, v145, v229
    v_mul_f32 v230, v146, v230
    v_mul_f32 v231, v147, v231
    v_mul_f32 v232, v148, v232
    ds_read_b64_tr_b16 v[180:181], v9 offset:57344
    ds_read_b64_tr_b16 v[182:183], v9 offset:57856
    s_waitcnt lgkmcnt(6)
    v_mfma_f32_32x32x16_bf16 v[152:167], v[168:171], v[104:107], v[152:167]
    v_mul_f32 v233, v149, v233
    v_mul_f32 v234, v150, v234
    v_mul_f32 v235, v151, v235
    v_exp_f32 v228, v228
    v_exp_f32 v229, v229
    v_mfma_f32_16x16x32_bf16 v[192:195], v[196:199], v[168:171], v[192:195]
    v_exp_f32 v230, v230
    v_exp_f32 v231, v231
    ds_read_b64_tr_b16 v[184:185], v10 offset:0
    ds_read_b64_tr_b16 v[186:187], v10 offset:512
    s_waitcnt lgkmcnt(6)
    v_mfma_f32_32x32x16_bf16 v[152:167], v[172:175], v[108:111], v[152:167]
    v_exp_f32 v232, v232
    v_exp_f32 v233, v233
    v_exp_f32 v234, v234
    v_exp_f32 v235, v235
    ds_read_b64_tr_b16 v[188:189], v11 offset:0
    ds_read_b64_tr_b16 v[190:191], v11 offset:512
    s_waitcnt lgkmcnt(6)
    v_mfma_f32_32x32x16_bf16 v[152:167], v[176:179], v[112:115], v[152:167]
    v_fma_f32 v228, v228, v210, v210
    v_fma_f32 v229, v229, v210, v210
    v_fma_f32 v230, v230, v210, v210
    v_fma_f32 v231, v231, v210, v210
    v_fma_f32 v232, v232, v210, v210
    v_fma_f32 v233, v233, v210, v210
    ds_read_b64_tr_b16 v[168:169], v12 offset:0
    ds_read_b64_tr_b16 v[170:171], v12 offset:512
    s_waitcnt lgkmcnt(6)
    v_mfma_f32_32x32x16_bf16 v[152:167], v[180:183], v[116:119], v[152:167]
    v_fma_f32 v234, v234, v210, v210
    v_fma_f32 v235, v235, v210, v210
    v_rcp_f32 v228, v228
    v_rcp_f32 v229, v229
    ds_read_b64_tr_b16 v[172:173], v13 offset:0
    ds_read_b64_tr_b16 v[174:175], v13 offset:512
    s_waitcnt lgkmcnt(6)
    v_mfma_f32_32x32x16_bf16 v[152:167], v[184:187], v[120:123], v[152:167]
    v_rcp_f32 v230, v230
    v_rcp_f32 v231, v231
    v_rcp_f32 v232, v232
    v_rcp_f32 v233, v233
    v_mfma_f32_16x16x32_bf16 v[192:195], v[196:199], v[184:187], v[192:195]
    v_rcp_f32 v234, v234
    v_rcp_f32 v235, v235
    ds_read_b64_tr_b16 v[176:177], v10 offset:8192
    ds_read_b64_tr_b16 v[178:179], v10 offset:8704
    s_waitcnt lgkmcnt(6)
    v_mfma_f32_32x32x16_bf16 v[152:167], v[188:191], v[124:127], v[152:167]
    v_mul_f32 v228, v144, v228
    v_mul_f32 v229, v145, v229
    v_mul_f32 v230, v146, v230
    v_mul_f32 v231, v147, v231
    v_mul_f32 v232, v148, v232
    ds_read_b64_tr_b16 v[180:181], v11 offset:8192
    ds_read_b64_tr_b16 v[182:183], v11 offset:8704
    s_waitcnt lgkmcnt(6)
    v_mfma_f32_32x32x16_bf16 v[152:167], v[168:171], v[128:131], v[152:167]
    v_mul_f32 v233, v149, v233
    v_mul_f32 v234, v150, v234
    v_mul_f32 v235, v151, v235
    v_cvt_pk_bf16_f32 v240, v228, v229
    ds_read_b64_tr_b16 v[184:185], v12 offset:8192
    ds_read_b64_tr_b16 v[186:187], v12 offset:8704
    s_waitcnt lgkmcnt(6)
    v_mfma_f32_32x32x16_bf16 v[152:167], v[172:175], v[132:135], v[152:167]
    v_cvt_pk_bf16_f32 v241, v230, v231
    v_cvt_pk_bf16_f32 v242, v232, v233
    v_cvt_pk_bf16_f32 v243, v234, v235
    buffer_store_dwordx4 v[240:243], v22, s[36:39], s88 offen offset:1024 sc1
    ds_write_b32 v23, v192 offset:1024
    ds_read_b64_tr_b16 v[188:189], v13 offset:8192
    ds_read_b64_tr_b16 v[190:191], v13 offset:8704
    s_waitcnt lgkmcnt(7)
    v_mfma_f32_32x32x16_bf16 v[136:151], v[176:179], v[24:27], 0
    v_mfma_f32_16x16x32_bf16 v[192:195], v[196:199], v[176:179], 0
    s_waitcnt vmcnt(7)
    s_waitcnt lgkmcnt(2)
    s_barrier
    ds_read_b128 v[236:239], v215 offset:1024
    s_mov_b32 s48, s16
    s_mov_b32 s49, s17
    s_mov_b32 s50, 1605632
    s_mov_b32 s51, 0x20000
    ds_read_b64_tr_b16 v[168:169], v10 offset:16384
    ds_read_b64_tr_b16 v[170:171], v10 offset:16896
    v_mfma_f32_32x32x16_bf16 v[136:151], v[180:183], v[28:31], v[136:151]
    ds_read_b64_tr_b16 v[172:173], v11 offset:16384
    ds_read_b64_tr_b16 v[174:175], v11 offset:16896
    v_mfma_f32_32x32x16_bf16 v[136:151], v[184:187], v[32:35], v[136:151]
    ds_read_b64_tr_b16 v[176:177], v12 offset:16384
    ds_read_b64_tr_b16 v[178:179], v12 offset:16896
    s_waitcnt lgkmcnt(7)
    v_mfma_f32_32x32x16_bf16 v[136:151], v[188:191], v[36:39], v[136:151]
    v_lshrrev_b32 v224, 5, v1
    v_lshlrev_b32 v224, 3, v224
    v_bfe_u32 v225, v1, 2, 2
    v_add_u32 v224, v224, v225
    v_lshlrev_b32 v224, 6, v224
    v_and_b32 v225, 16, v1
    v_lshl_add_u32 v224, v225, 1, v224
    v_and_b32 v225, 3, v1
    v_lshl_add_u32 v224, v225, 3, v224
    s_xor_b32 s69, s27, s26
    s_lshl_b32 s69, s69, 10
    s_add_u32 s69, s69, 131072
    v_add_u32 v18, s69, v224
    v_xor_b32 v19, 0x400, v18
    v_xor_b32 v20, 0x800, v18
    v_xor_b32 v21, 0xc00, v18
    v_mov_b32 v224, 161792
    v_mov_b32 v226, 0
    v_mov_b32 v227, 0
    ds_write_b64 v224, v[226:227]
    ds_write_b32 v224, v226 offset:8
    ds_write_b32 v224, v226 offset:2032
    v_lshlrev_b32 v228, 16, v212
    v_mov_b32 v206, v212
    s_waitcnt lgkmcnt(9)
    v_add_f32 v224, v236, v237
    v_add_f32 v226, v238, v239
    ds_read_b64_tr_b16 v[180:181], v13 offset:16384
    ds_read_b64_tr_b16 v[182:183], v13 offset:16896
    s_waitcnt lgkmcnt(9)
    v_mfma_f32_32x32x16_bf16 v[136:151], v[168:171], v[40:43], v[136:151]
    v_add_f32 v224, v224, v226
    v_cvt_pk_bf16_f32 v204, v224, v224
    v_lshlrev_b32 v225, 16, v204
    v_sub_f32 v225, v224, v225
    v_cvt_pk_bf16_f32 v205, v225, v228
    s_add_u32 s88, s76, 4096
    s_nop 0
    v_mfma_f32_16x16x32_bf16 v[192:195], v[196:199], v[168:171], v[192:195]
    v_mfma_f32_32x32x16_bf16 v[152:167], v[204:207], v[200:203], v[152:167]
    s_cmp_eq_u32 s27, 0
    s_cbranch_scc0 L_site13
    s_add_u32 m0, s0, s98
    s_nop 0
    buffer_load_dwordx4 v249, s[48:51], s80 offen lds
    s_add_u32 m0, s1, s98
    s_nop 0
    buffer_load_dwordx4 v249, s[48:51], s81 offen lds
    s_add_u32 m0, s3, s98
    s_nop 0
    buffer_load_dwordx4 v249, s[48:51], s82 offen lds
    s_add_u32 m0, s13, s98
    s_nop 0
    buffer_load_dwordx4 v249, s[48:51], s83 offen lds
    s_add_u32 m0, s14, s98
    s_nop 0
    buffer_load_dwordx4 v249, s[48:51], s84 offen lds
    s_add_u32 m0, s15, s98
    s_nop 0
    buffer_load_dwordx4 v249, s[48:51], s85 offen lds
    s_add_u32 m0, s22, s98
    s_nop 0
    buffer_load_dwordx4 v249, s[48:51], s86 offen lds
    s_add_u32 m0, s23, s98
    s_nop 0
    buffer_load_dwordx4 v249, s[48:51], s87 offen lds
L_site13:
    s_nop 9
    v_mul_f32 v228, v152, v152
    v_mul_f32 v229, v153, v153
    ds_read_b64_tr_b16 v[184:185], v10 offset:24576
    ds_read_b64_tr_b16 v[186:187], v10 offset:25088
    s_waitcnt lgkmcnt(9)
    v_mfma_f32_32x32x16_bf16 v[136:151], v[172:175], v[44:47], v[136:151]
    v_mul_f32 v230, v154, v154
    v_mul_f32 v231, v155, v155
    v_mul_f32 v232, v156, v156
    v_mul_f32 v233, v157, v157
    v_mul_f32 v234, v158, v158
    v_mul_f32 v235, v159, v159
    v_fma_f32 v228, v228, v209, v208
    ds_read_b64_tr_b16 v[188:189], v11 offset:24576
    ds_read_b64_tr_b16 v[190:191], v11 offset:25088
    s_waitcnt lgkmcnt(9)
    v_mfma_f32_32x32x16_bf16 v[136:151], v[176:179], v[48:51], v[136:151]
    v_fma_f32 v229, v229, v209, v208
    v_fma_f32 v230, v230, v209, v208
    v_fma_f32 v231, v231, v209, v208
    v_fma_f32 v232, v232, v209, v208
    v_fma_f32 v233, v233, v209, v208
    v_fma_f32 v234, v234, v209, v208
    v_fma_f32 v235, v235, v209, v208
    ds_read_b64_tr_b16 v[168:169], v12 offset:24576
    ds_read_b64_tr_b16 v[170:171], v12 offset:25088
    s_waitcnt lgkmcnt(6)
    v_mfma_f32_32x32x16_bf16 v[136:151], v[180:183], v[52:55], v[136:151]
    v_mul_f32 v228, v152, v228
    v_mul_f32 v229, v153, v229
    v_mul_f32 v230, v154, v230
    v_mul_f32 v231, v155, v231
    v_mul_f32 v232, v156, v232
    v_mul_f32 v233, v157, v233
    v_mul_f32 v234, v158, v234
    ds_read_b64_tr_b16 v[172:173], v13 offset:24576
    ds_read_b64_tr_b16 v[174:175], v13 offset:25088
    s_waitcnt lgkmcnt(6)
    v_mfma_f32_32x32x16_bf16 v[136:151], v[184:187], v[56:59], v[136:151]
    v_mul_f32 v235, v159, v235
    v_exp_f32 v228, v228
    v_exp_f32 v229, v229
    v_exp_f32 v230, v230
    v_mfma_f32_16x16x32_bf16 v[192:195], v[196:199], v[184:187], v[192:195]
    v_exp_f32 v231, v231
    v_exp_f32 v232, v232
    ds_read_b64_tr_b16 v[176:177], v10 offset:32768
    ds_read_b64_tr_b16 v[178:179], v10 offset:33280
    s_waitcnt lgkmcnt(6)
    v_mfma_f32_32x32x16_bf16 v[136:151], v[188:191], v[60:63], v[136:151]
    v_exp_f32 v233, v233
    v_exp_f32 v234, v234
    v_exp_f32 v235, v235
    v_fma_f32 v228, v228, v210, v210
    ds_read_b64_tr_b16 v[180:181], v11 offset:32768
    ds_read_b64_tr_b16 v[182:183], v11 offset:33280
    s_waitcnt lgkmcnt(6)
    v_mfma_f32_32x32x16_bf16 v[136:151], v[168:171], v[64:67], v[136:151]
    v_fma_f32 v229, v229, v210, v210
    v_fma_f32 v230, v230, v210, v210
    v_fma_f32 v231, v231, v210, v210
    v_fma_f32 v232, v232, v210, v210
    v_fma_f32 v233, v233, v210, v210
    v_fma_f32 v234, v234, v210, v210
    v_fma_f32 v235, v235, v210, v210
    ds_read_b64_tr_b16 v[184:185], v12 offset:32768
    ds_read_b64_tr_b16 v[186:187], v12 offset:33280
    s_waitcnt lgkmcnt(6)
    v_mfma_f32_32x32x16_bf16 v[136:151], v[172:175], v[68:71], v[136:151]
    v_rcp_f32 v228, v228
    v_rcp_f32 v229, v229
    v_rcp_f32 v230, v230
    ds_read_b64_tr_b16 v[188:189], v13 offset:32768
    ds_read_b64_tr_b16 v[190:191], v13 offset:33280
    s_waitcnt lgkmcnt(6)
    v_mfma_f32_32x32x16_bf16 v[136:151], v[176:179], v[72:75], v[136:151]
    v_rcp_f32 v231, v231
    v_rcp_f32 v232, v232
    v_rcp_f32 v233, v233
    v_rcp_f32 v234, v234
    v_mfma_f32_16x16x32_bf16 v[192:195], v[196:199], v[176:179], v[192:195]
    v_rcp_f32 v235, v235
    v_mul_f32 v228, v152, v228
    ds_read_b64_tr_b16 v[168:169], v10 offset:40960
    ds_read_b64_tr_b16 v[170:171], v10 offset:41472
    s_waitcnt lgkmcnt(6)
    v_mfma_f32_32x32x16_bf16 v[136:151], v[180:183], v[76:79], v[136:151]
    v_mul_f32 v229, v153, v229
    v_mul_f32 v230, v154, v230
    v_mul_f32 v231, v155, v231
    v_mul_f32 v232, v156, v232
    v_mul_f32 v233, v157, v233
    v_mul_f32 v234, v158, v234
    ds_read_b64_tr_b16 v[172:173], v11 offset:40960
    ds_read_b64_tr_b16 v[174:175], v11 offset:41472
    s_waitcnt lgkmcnt(6)
    v_mfma_f32_32x32x16_bf16 v[136:151], v[184:187], v[80:83], v[136:151]
    v_mul_f32 v235, v159, v235
    v_cvt_pk_bf16_f32 v236, v228, v229
    v_cvt_pk_bf16_f32 v237, v230, v231
    v_cvt_pk_bf16_f32 v238, v232, v233
    v_cvt_pk_bf16_f32 v239, v234, v235
    buffer_store_dwordx4 v[236:239], v22, s[36:39], s88 offen offset:0 sc1
    ds_read_b64_tr_b16 v[176:177], v12 offset:40960
    ds_read_b64_tr_b16 v[178:179], v12 offset:41472
    s_waitcnt lgkmcnt(6)
    v_mfma_f32_32x32x16_bf16 v[136:151], v[188:191], v[84:87], v[136:151]
    s_cmp_eq_u32 s27, 1
    s_cbranch_scc0 L_site14
    s_add_u32 m0, s0, s98
    s_nop 0
    buffer_load_dwordx4 v249, s[48:51], s80 offen lds
    s_add_u32 m0, s1, s98
    s_nop 0
    buffer_load_dwordx4 v249, s[48:51], s81 offen lds
    s_add_u32 m0, s3, s98
    s_nop 0
    buffer_load_dwordx4 v249, s[48:51], s82 offen lds
    s_add_u32 m0, s13, s98
    s_nop 0
    buffer_load_dwordx4 v249, s[48:51], s83 offen lds
    s_add_u32 m0, s14, s98
    s_nop 0
    buffer_load_dwordx4 v249, s[48:51], s84 offen lds
    s_add_u32 m0, s15, s98
    s_nop 0
    buffer_load_dwordx4 v249, s[48:51], s85 offen lds
    s_add_u32 m0, s22, s98
    s_nop 0
    buffer_load_dwordx4 v249, s[48:51], s86 offen lds
    s_add_u32 m0, s23, s98
    s_nop 0
    buffer_load_dwordx4 v249, s[48:51], s87 offen lds
L_site14:
    v_mul_f32 v228, v160, v160
    v_mul_f32 v229, v161, v161
    v_mul_f32 v230, v162, v162
    v_mul_f32 v231, v163, v163
    v_mul_f32 v232, v164, v164
    ds_read_b64_tr_b16 v[180:181], v13 offset:40960
    ds_read_b64_tr_b16 v[182:183], v13 offset:41472
    s_waitcnt lgkmcnt(6)
    v_mfma_f32_32x32x16_bf16 v[136:151], v[168:171], v[88:91], v[136:151]
    v_mul_f32 v233, v165, v165
    v_mul_f32 v234, v166, v166
    v_mul_f32 v235, v167, v167
    v_fma_f32 v228, v228, v209, v208
    v_fma_f32 v229, v229, v209, v208
    v_fma_f32 v230, v230, v209, v208
    v_mfma_f32_16x16x32_bf16 v[192:195], v[196:199], v[168:171], v[192:195]
    v_fma_f32 v231, v231, v209, v208
    v_fma_f32 v232, v232, v209, v208
    v_fma_f32 v233, v233, v209, v208
    ds_read_b64_tr_b16 v[184:185], v10 offset:49152
    ds_read_b64_tr_b16 v[186:187], v10 offset:49664
    s_waitcnt lgkmcnt(6)
    v_mfma_f32_32x32x16_bf16 v[136:151], v[172:175], v[92:95], v[136:151]
    v_fma_f32 v234, v234, v209, v208
    v_fma_f32 v235, v235, v209, v208
    v_mul_f32 v228, v160, v228
    v_mul_f32 v229, v161, v229
    v_mul_f32 v230, v162, v230
    v_mul_f32 v231, v163, v231
    ds_read_b64_tr_b16 v[188:189], v11 offset:49152
    ds_read_b64_tr_b16 v[190:191], v11 offset:49664
    s_waitcnt lgkmcnt(6)
    v_mfma_f32_32x32x16_bf16 v[136:151], v[176:179], v[96:99], v[136:151]
    v_mul_f32 v232, v164, v232
    v_mul_f32 v233, v165, v233
    v_mul_f32 v234, v166, v234
    v_mul_f32 v235, v167, v235
    v_exp_f32 v228, v228
    ds_read_b64_tr_b16 v[168:169], v12 offset:49152
    ds_read_b64_tr_b16 v[170:171], v12 offset:49664
    s_waitcnt lgkmcnt(6)
    v_mfma_f32_32x32x16_bf16 v[136:151], v[180:183], v[100:103], v[136:151]
    v_exp_f32 v229, v229
    v_exp_f32 v230, v230
    v_exp_f32 v231, v231
    ds_read_b64_tr_b16 v[172:173], v13 offset:49152
    ds_read_b64_tr_b16 v[174:175], v13 offset:49664
    s_waitcnt lgkmcnt(6)
    v_mfma_f32_32x32x16_bf16 v[136:151], v[184:187], v[104:107], v[136:151]
    v_exp_f32 v232, v232
    v_exp_f32 v233, v233
    v_exp_f32 v234, v234
    v_mfma_f32_16x16x32_bf16 v[192:195], v[196:199], v[184:187], v[192:195]
    v_exp_f32 v235, v235
    v_fma_f32 v228, v228, v210, v210
    ds_read_b64_tr_b16 v[176:177], v10 offset:57344
    ds_read_b64_tr_b16 v[178:179], v10 offset:57856
    s_waitcnt lgkmcnt(6)
    v_mfma_f32_32x32x16_bf16 v[136:151], v[188:191], v[108:111], v[136:151]
    v_fma_f32 v229, v229, v210, v210
    v_fma_f32 v230, v230, v210, v210
    v_fma_f32 v231, v231, v210, v210
    v_fma_f32 v232, v232, v210, v210
    v_fma_f32 v233, v233, v210, v210
    v_fma_f32 v234, v234, v210, v210
    ds_read_b64_tr_b16 v[180:181], v11 offset:57344
    ds_read_b64_tr_b16 v[182:183], v11 offset:57856
    s_waitcnt lgkmcnt(6)
    v_mfma_f32_32x32x16_bf16 v[136:151], v[168:171], v[112:115], v[136:151]
    v_fma_f32 v235, v235, v210, v210
    v_rcp_f32 v228, v228
    v_rcp_f32 v229, v229
    ds_read_b64_tr_b16 v[184:185], v12 offset:57344
    ds_read_b64_tr_b16 v[186:187], v12 offset:57856
    s_waitcnt lgkmcnt(6)
    v_mfma_f32_32x32x16_bf16 v[136:151], v[172:175], v[116:119], v[136:151]
    v_rcp_f32 v230, v230
    v_rcp_f32 v231, v231
    v_rcp_f32 v232, v232
    ds_read_b64_tr_b16 v[188:189], v13 offset:57344
    ds_read_b64_tr_b16 v[190:191], v13 offset:57856
    s_waitcnt lgkmcnt(6)
    v_mfma_f32_32x32x16_bf16 v[136:151], v[176:179], v[120:123], v[136:151]
    v_rcp_f32 v233, v233
    v_rcp_f32 v234, v234
    v_rcp_f32 v235, v235
    v_mfma_f32_16x16x32_bf16 v[192:195], v[196:199], v[176:179], v[192:195]
    v_mul_f32 v228, v160, v228
    v_mul_f32 v229, v161, v229
    v_mul_f32 v230, v162, v230
    ds_read_b64_tr_b16 v[168:169], v18 offset:0
    ds_read_b64_tr_b16 v[170:171], v18 offset:256
    s_waitcnt lgkmcnt(6)
    v_mfma_f32_32x32x16_bf16 v[136:151], v[180:183], v[124:127], v[136:151]
    v_mul_f32 v231, v163, v231
    v_mul_f32 v232, v164, v232
    v_mul_f32 v233, v165, v233
    v_mul_f32 v234, v166, v234
    ds_read_b64_tr_b16 v[172:173], v19 offset:0
    ds_read_b64_tr_b16 v[174:175], v19 offset:256
    s_waitcnt lgkmcnt(6)
    v_mfma_f32_32x32x16_bf16 v[136:151], v[184:187], v[128:131], v[136:151]
    v_mul_f32 v235, v167, v235
    v_cvt_pk_bf16_f32 v240, v228, v229
    v_cvt_pk_bf16_f32 v241, v230, v231
    ds_read_b64_tr_b16 v[176:177], v20 offset:0
    ds_read_b64_tr_b16 v[178:179], v20 offset:256
    s_waitcnt lgkmcnt(6)
    v_mfma_f32_32x32x16_bf16 v[136:151], v[188:191], v[132:135], v[136:151]
    v_cvt_pk_bf16_f32 v242, v232, v233
    v_cvt_pk_bf16_f32 v243, v234, v235
    buffer_store_dwordx4 v[240:243], v22, s[36:39], s88 offen offset:1024 sc1
    ds_write_b32 v23, v192 offset:0
    s_cmp_eq_u32 s27, 0
    s_cbranch_scc0 L_mlp_g1
    ds_read_b64_tr_b16 v[180:181], v21 offset:0
    ds_read_b64_tr_b16 v[182:183], v21 offset:256
    s_waitcnt lgkmcnt(7)
    v_mfma_f32_32x32x16_bf16 v[152:167], v[168:171], v[24:27], 0
    v_mfma_f32_16x16x32_bf16 v[192:195], v[196:199], v[168:171], 0
    s_waitcnt vmcnt(1)
    s_waitcnt lgkmcnt(2)
    s_barrier
    s_cmp_eq_u32 s64, 4
    s_cbranch_scc0 L_svc15
    s_lshl_b32 s69, s67, 7
    s_add_u32 s69, s69, 9437184
    v_mov_b32 v253, 1
    s_mov_b64 exec, 1
    buffer_atomic_add v253, off, s[36:39], s69 sc1
    s_mov_b64 exec, -1
L_svc15:
    ds_read_b128 v[236:239], v215 offset:0
    ds_read_b64_tr_b16 v[184:185], v18 offset:4096
    ds_read_b64_tr_b16 v[186:187], v18 offset:4352
    v_mfma_f32_32x32x16_bf16 v[152:167], v[172:175], v[28:31], v[152:167]
    ds_read_b64_tr_b16 v[188:189], v19 offset:4096
    ds_read_b64_tr_b16 v[190:191], v19 offset:4352
    v_mfma_f32_32x32x16_bf16 v[152:167], v[176:179], v[32:35], v[152:167]
    ds_read_b64_tr_b16 v[168:169], v20 offset:4096
    ds_read_b64_tr_b16 v[170:171], v20 offset:4352
    s_waitcnt lgkmcnt(7)
    v_mfma_f32_32x32x16_bf16 v[152:167], v[180:183], v[36:39], v[152:167]
    v_lshlrev_b32 v228, 16, v213
    v_mov_b32 v206, v213
    s_waitcnt lgkmcnt(6)
    v_add_f32 v224, v236, v237
    v_add_f32 v226, v238, v239
    v_add_f32 v224, v224, v226
    ds_read_b64_tr_b16 v[172:173], v21 offset:4096
    ds_read_b64_tr_b16 v[174:175], v21 offset:4352
    s_waitcnt lgkmcnt(6)
    v_mfma_f32_32x32x16_bf16 v[152:167], v[184:187], v[40:43], v[152:167]
    v_cvt_pk_bf16_f32 v204, v224, v224
    v_lshlrev_b32 v225, 16, v204
    v_sub_f32 v225, v224, v225
    v_cvt_pk_bf16_f32 v205, v225, v228
    s_add_u32 s88, s76, 8192
    s_nop 0
    v_mfma_f32_32x32x16_bf16 v[136:151], v[204:207], v[200:203], v[136:151]
    v_mfma_f32_16x16x32_bf16 v[192:195], v[196:199], v[184:187], v[192:195]
    s_nop 10
    v_mul_f32 v228, v136, v136
    v_mul_f32 v229, v137, v137
    v_mul_f32 v230, v138, v138
    v_mul_f32 v231, v139, v139
    ds_read_b64_tr_b16 v[176:177], v18 offset:8192
    ds_read_b64_tr_b16 v[178:179], v18 offset:8448
    s_waitcnt lgkmcnt(6)
    v_mfma_f32_32x32x16_bf16 v[152:167], v[188:191], v[44:47], v[152:167]
    v_mul_f32 v232, v140, v140
    v_mul_f32 v233, v141, v141
    v_mul_f32 v234, v142, v142
    v_mul_f32 v235, v143, v143
    v_fma_f32 v228, v228, v209, v208
    v_fma_f32 v229, v229, v209, v208
    v_fma_f32 v230, v230, v209, v208
    ds_read_b64_tr_b16 v[180:181], v19 offset:8192
    ds_read_b64_tr_b16 v[182:183], v19 offset:8448
    s_waitcnt lgkmcnt(6)
    v_mfma_f32_32x32x16_bf16 v[152:167], v[168:171], v[48:51], v[152:167]
    v_fma_f32 v231, v231, v209, v208
    v_fma_f32 v232, v232, v209, v208
    v_fma_f32 v233, v233, v209, v208
    v_fma_f32 v234, v234, v209, v208
    v_fma_f32 v235, v235, v209, v208
    v_mul_f32 v228, v136, v228
    v_mul_f32 v229, v137, v229
    ds_read_b64_tr_b16 v[184:185], v20 offset:8192
    ds_read_b64_tr_b16 v[186:187], v20 offset:8448
    s_waitcnt lgkmcnt(6)
    v_mfma_f32_32x32x16_bf16 v[152:167], v[172:175], v[52:55], v[152:167]
    v_mul_f32 v230, v138, v230
    v_mul_f32 v231, v139, v231
    v_mul_f32 v232, v140, v232
    v_mul_f32 v233, v141, v233
    v_mul_f32 v234, v142, v234
    v_mul_f32 v235, v143, v235
    v_exp_f32 v228, v228
    s_waitcnt vmcnt(0)
    v_mov_b32 v218, 161792
    v_mov_b32 v219, 1
    s_mov_b64 exec, 1
    ds_add_rtn_u32 v219, v218, v219
    s_mov_b64 exec, -1
    ds_read_b64_tr_b16 v[188:189], v21 offset:8192
    ds_read_b64_tr_b16 v[190:191], v21 offset:8448
    s_waitcnt lgkmcnt(7)
    v_mfma_f32_32x32x16_bf16 v[152:167], v[176:179], v[56:59], v[152:167]
    v_exp_f32 v229, v229
    v_exp_f32 v230, v230
    v_exp_f32 v231, v231
    v_exp_f32 v232, v232
    v_mfma_f32_16x16x32_bf16 v[192:195], v[196:199], v[176:179], v[192:195]
    v_exp_f32 v233, v233
    v_exp_f32 v234, v234
    ds_read_b64_tr_b16 v[168:169], v18 offset:12288
    ds_read_b64_tr_b16 v[170:171], v18 offset:12544
    s_waitcnt lgkmcnt(7)
    v_mfma_f32_32x32x16_bf16 v[152:167], v[180:183], v[60:63], v[152:167]
    v_exp_f32 v235, v235
    v_fma_f32 v228, v228, v210, v210
    v_fma_f32 v229, v229, v210, v210
    v_fma_f32 v230, v230, v210, v210
    v_fma_f32 v231, v231, v210, v210
    ds_read_b64_tr_b16 v[172:173], v19 offset:12288
    ds_read_b64_tr_b16 v[174:175], v19 offset:12544
    s_waitcnt lgkmcnt(7)
    v_mfma_f32_32x32x16_bf16 v[152:167], v[184:187], v[64:67], v[152:167]
    v_fma_f32 v232, v232, v210, v210
    v_fma_f32 v233, v233, v210, v210
    v_fma_f32 v234, v234, v210, v210
    v_fma_f32 v235, v235, v210, v210
    v_rcp_f32 v228, v228
    s_waitcnt lgkmcnt(6)
    v_readfirstlane_b32 s69, v219
    s_nop 0
    s_cmp_eq_u32 s69, 7
    s_cbranch_scc0 L_ar16
    s_lshl_b32 s69, s67, 7
    s_add_u32 s69, s69, 9441280
    v_mov_b32 v253, 1
    s_mov_b64 exec, 1
    buffer_atomic_add v253, off, s[36:39], s69 sc1
    s_mov_b64 exec, -1
L_ar16:
    ds_read_b64_tr_b16 v[176:177], v20 offset:12288
    ds_read_b64_tr_b16 v[178:179], v20 offset:12544
    s_waitcnt lgkmcnt(6)
    v_mfma_f32_32x32x16_bf16 v[152:167], v[188:191], v[68:71], v[152:167]
    v_rcp_f32 v229, v229
    v_rcp_f32 v230, v230
    v_rcp_f32 v231, v231
    ds_read_b64_tr_b16 v[180:181], v21 offset:12288
    ds_read_b64_tr_b16 v[182:183], v21 offset:12544
    s_waitcnt lgkmcnt(6)
    v_mfma_f32_32x32x16_bf16 v[152:167], v[168:171], v[72:75], v[152:167]
    v_rcp_f32 v232, v232
    v_rcp_f32 v233, v233
    v_rcp_f32 v234, v234
    v_mfma_f32_16x16x32_bf16 v[192:195], v[196:199], v[168:171], v[192:195]
    v_rcp_f32 v235, v235
    v_mul_f32 v228, v136, v228
    ds_read_b64_tr_b16 v[184:185], v18 offset:16384
    ds_read_b64_tr_b16 v[186:187], v18 offset:16640
    s_waitcnt lgkmcnt(6)
    v_mfma_f32_32x32x16_bf16 v[152:167], v[172:175], v[76:79], v[152:167]
    v_mul_f32 v229, v137, v229
    v_mul_f32 v230, v138, v230
    v_mul_f32 v231, v139, v231
    v_mul_f32 v232, v140, v232
    v_mul_f32 v233, v141, v233
    v_mul_f32 v234, v142, v234
    ds_read_b64_tr_b16 v[188:189], v19 offset:16384
    ds_read_b64_tr_b16 v[190:191], v19 offset:16640
    s_waitcnt lgkmcnt(6)
    v_mfma_f32_32x32x16_bf16 v[152:167], v[176:179], v[80:83], v[152:167]
    v_mul_f32 v235, v143, v235
    v_cvt_pk_bf16_f32 v236, v228, v229
    v_cvt_pk_bf16_f32 v237, v230, v231
    v_cvt_pk_bf16_f32 v238, v232, v233
    v_cvt_pk_bf16_f32 v239, v234, v235
    buffer_store_dwordx4 v[236:239], v22, s[36:39], s88 offen offset:0 sc1
    ds_read_b64_tr_b16 v[168:169], v20 offset:16384
    ds_read_b64_tr_b16 v[170:171], v20 offset:16640
    s_waitcnt lgkmcnt(6)
    v_mfma_f32_32x32x16_bf16 v[152:167], v[180:183], v[84:87], v[152:167]
    v_mul_f32 v228, v144, v144
    v_mul_f32 v229, v145, v145
    v_mul_f32 v230, v146, v146
    v_mul_f32 v231, v147, v147
    v_mul_f32 v232, v148, v148
    v_mul_f32 v233, v149, v149
    ds_read_b64_tr_b16 v[172:173], v21 offset:16384
    ds_read_b64_tr_b16 v[174:175], v21 offset:16640
    s_waitcnt lgkmcnt(6)
    v_mfma_f32_32x32x16_bf16 v[152:167], v[184:187], v[88:91], v[152:167]
    v_mul_f32 v234, v150, v150
    v_mul_f32 v235, v151, v151
    v_fma_f32 v228, v228, v209, v208
    v_fma_f32 v229, v229, v209, v208
    v_fma_f32 v230, v230, v209, v208
    v_fma_f32 v231, v231, v209, v208
    v_mfma_f32_16x16x32_bf16 v[192:195], v[196:199], v[184:187], v[192:195]
    v_fma_f32 v232, v232, v209, v208
    v_fma_f32 v233, v233, v209, v208
    v_fma_f32 v234, v234, v209, v208
    ds_read_b64_tr_b16 v[176:177], v18 offset:20480
    ds_read_b64_tr_b16 v[178:179], v18 offset:20736
    s_waitcnt lgkmcnt(6)
    v_mfma_f32_32x32x16_bf16 v[152:167], v[188:191], v[92:95], v[152:167]
    v_fma_f32 v235, v235, v209, v208
    v_mul_f32 v228, v144, v228
    v_mul_f32 v229, v145, v229
    v_mul_f32 v230, v146, v230
    v_mul_f32 v231, v147, v231
    v_mul_f32 v232, v148, v232
    ds_read_b64_tr_b16 v[180:181], v19 offset:20480
    ds_read_b64_tr_b16 v[182:183], v19 offset:20736
    s_waitcnt lgkmcnt(6)
    v_mfma_f32_32x32x16_bf16 v[152:167], v[168:171], v[96:99], v[152:167]
    v_mul_f32 v233, v149, v233
    v_mul_f32 v234, v150, v234
    v_mul_f32 v235, v151, v235
    v_exp_f32 v228, v228
    v_exp_f32 v229, v229
    ds_read_b64_tr_b16 v[184:185], v20 offset:20480
    ds_read_b64_tr_b16 v[186:187], v20 offset:20736
    s_waitcnt lgkmcnt(6)
    v_mfma_f32_32x32x16_bf16 v[152:167], v[172:175], v[100:103], v[152:167]
    v_exp_f32 v230, v230
    v_exp_f32 v231, v231
    v_exp_f32 v232, v232
    ds_read_b64_tr_b16 v[188:189], v21 offset:20480
    ds_read_b64_tr_b16 v[190:191], v21 offset:20736
    s_waitcnt lgkmcnt(6)
    v_mfma_f32_32x32x16_bf16 v[152:167], v[176:179], v[104:107], v[152:167]
    v_exp_f32 v233, v233
    v_exp_f32 v234, v234
    v_exp_f32 v235, v235
    v_mfma_f32_16x16x32_bf16 v[192:195], v[196:199], v[176:179], v[192:195]
    v_fma_f32 v228, v228, v210, v210
    v_fma_f32 v229, v229, v210, v210
    v_fma_f32 v230, v230, v210, v210
    ds_read_b64_tr_b16 v[168:169], v18 offset:24576
    ds_read_b64_tr_b16 v[170:171], v18 offset:24832
    s_waitcnt lgkmcnt(6)
    v_mfma_f32_32x32x16_bf16 v[152:167], v[180:183], v[108:111], v[152:167]
    v_fma_f32 v231, v231, v210, v210
    v_fma_f32 v232, v232, v210, v210
    v_fma_f32 v233, v233, v210, v210
    v_fma_f32 v234, v234, v210, v210
    v_fma_f32 v235, v235, v210, v210
    ds_read_b64_tr_b16 v[172:173], v19 offset:24576
    ds_read_b64_tr_b16 v[174:175], v19 offset:24832
    s_waitcnt lgkmcnt(6)
    v_mfma_f32_32x32x16_bf16 v[152:167], v[184:187], v[112:115], v[152:167]
    v_rcp_f32 v228, v228
    v_rcp_f32 v229, v229
    v_rcp_f32 v230, v230
    ds_read_b64_tr_b16 v[176:177], v20 offset:24576
    ds_read_b64_tr_b16 v[178:179], v20 offset:24832
    s_waitcnt lgkmcnt(6)
    v_mfma_f32_32x32x16_bf16 v[152:167], v[188:191], v[116:119], v[152:167]
    v_rcp_f32 v231, v231
    v_rcp_f32 v232, v232
    v_rcp_f32 v233, v233
    ds_read_b64_tr_b16 v[180:181], v21 offset:24576
    ds_read_b64_tr_b16 v[182:183], v21 offset:24832
    s_waitcnt lgkmcnt(6)
    v_mfma_f32_32x32x16_bf16 v[152:167], v[168:171], v[120:123], v[152:167]
    v_rcp_f32 v234, v234
    v_rcp_f32 v235, v235
    v_mul_f32 v228, v144, v228
    v_mfma_f32_16x16x32_bf16 v[192:195], v[196:199], v[168:171], v[192:195]
    v_mul_f32 v229, v145, v229
    v_mul_f32 v230, v146, v230
    v_mul_f32 v231, v147, v231
    s_waitcnt lgkmcnt(4)
    v_mfma_f32_32x32x16_bf16 v[152:167], v[172:175], v[124:127], v[152:167]
    v_mul_f32 v232, v148, v232
    v_mul_f32 v233, v149, v233
    v_mul_f32 v234, v150, v234
    v_mul_f32 v235, v151, v235
    s_waitcnt lgkmcnt(2)
    v_mfma_f32_32x32x16_bf16 v[152:167], v[176:179], v[128:131], v[152:167]
    v_cvt_pk_bf16_f32 v240, v228, v229
    v_cvt_pk_bf16_f32 v241, v230, v231
    v_cvt_pk_bf16_f32 v242, v232, v233
    s_waitcnt lgkmcnt(0)
    v_mfma_f32_32x32x16_bf16 v[152:167], v[180:183], v[132:135], v[152:167]
    v_cvt_pk_bf16_f32 v243, v234, v235
    buffer_store_dwordx4 v[240:243], v22, s[36:39], s88 offen offset:1024 sc1
    ds_write_b32 v23, v192 offset:1024
    s_waitcnt lgkmcnt(0)
    v_mov_b32 v218, 161796
    v_mov_b32 v219, 1
    s_mov_b64 exec, 1
    ds_add_u32 v218, v219
    s_mov_b64 exec, -1
    s_mov_b32 s71, 400000
L_g0s:
    ds_read_b32 v219, v218
    s_sub_u32 s71, s71, 1
    s_cbranch_scc1 L_g0x
    s_waitcnt lgkmcnt(0)
    v_readfirstlane_b32 s69, v219
    s_nop 0
    s_cmp_ge_u32 s69, 4
    s_cbranch_scc0 L_g0s
L_g0x:
    ds_read_b128 v[236:239], v215 offset:1024
    v_lshlrev_b32 v228, 16, v214
    v_mov_b32 v206, v214
    s_waitcnt lgkmcnt(0)
    v_add_f32 v224, v236, v237
    v_add_f32 v226, v238, v239
    v_add_f32 v224, v224, v226
    v_cvt_pk_bf16_f32 v204, v224, v224
    v_lshlrev_b32 v225, 16, v204
    v_sub_f32 v225, v224, v225
    v_cvt_pk_bf16_f32 v205, v225, v228
    s_mov_b32 s88, s77
    s_nop 0
    v_mfma_f32_32x32x16_bf16 v[152:167], v[204:207], v[200:203], v[152:167]
    s_nop 11
    v_pk_mul_f32 v[228:229], v[152:153], v[152:153]
    v_pk_mul_f32 v[230:231], v[154:155], v[154:155]
    v_pk_mul_f32 v[232:233], v[156:157], v[156:157]
    v_pk_mul_f32 v[234:235], v[158:159], v[158:159]
    v_pk_fma_f32 v[228:229], v[228:229], v[208:209], v[208:209] op_sel:[0,1,0] op_sel_hi:[1,1,0]
    v_pk_fma_f32 v[230:231], v[230:231], v[208:209], v[208:209] op_sel:[0,1,0] op_sel_hi:[1,1,0]
    v_pk_fma_f32 v[232:233], v[232:233], v[208:209], v[208:209] op_sel:[0,1,0] op_sel_hi:[1,1,0]
    v_pk_fma_f32 v[234:235], v[234:235], v[208:209], v[208:209] op_sel:[0,1,0] op_sel_hi:[1,1,0]
    v_pk_mul_f32 v[228:229], v[152:153], v[228:229]
    v_pk_mul_f32 v[230:231], v[154:155], v[230:231]
    v_pk_mul_f32 v[232:233], v[156:157], v[232:233]
    v_pk_mul_f32 v[234:235], v[158:159], v[234:235]
    v_exp_f32 v228, v228
    v_exp_f32 v229, v229
    v_exp_f32 v230, v230
    v_exp_f32 v231, v231
    v_exp_f32 v232, v232
    v_exp_f32 v233, v233
    v_exp_f32 v234, v234
    v_exp_f32 v235, v235
    v_pk_fma_f32 v[228:229], v[228:229], v[210:211], v[210:211] op_sel_hi:[1,0,0]
    v_pk_fma_f32 v[230:231], v[230:231], v[210:211], v[210:211] op_sel_hi:[1,0,0]
    v_pk_fma_f32 v[232:233], v[232:233], v[210:211], v[210:211] op_sel_hi:[1,0,0]
    v_pk_fma_f32 v[234:235], v[234:235], v[210:211], v[210:211] op_sel_hi:[1,0,0]
    v_rcp_f32 v228, v228
    v_rcp_f32 v229, v229
    v_rcp_f32 v230, v230
    v_rcp_f32 v231, v231
    v_rcp_f32 v232, v232
    v_rcp_f32 v233, v233
    v_rcp_f32 v234, v234
    v_rcp_f32 v235, v235
    v_pk_mul_f32 v[228:229], v[152:153], v[228:229]
    v_pk_mul_f32 v[230:231], v[154:155], v[230:231]
    v_pk_mul_f32 v[232:233], v[156:157], v[232:233]
    v_pk_mul_f32 v[234:235], v[158:159], v[234:235]
    v_cvt_pk_bf16_f32 v236, v228, v229
    v_cvt_pk_bf16_f32 v237, v230, v231
    v_cvt_pk_bf16_f32 v238, v232, v233
    v_cvt_pk_bf16_f32 v239, v234, v235
    buffer_store_dwordx4 v[236:239], v22, s[36:39], s88 offen offset:0 sc1
    v_pk_mul_f32 v[228:229], v[160:161], v[160:161]
    v_pk_mul_f32 v[230:231], v[162:163], v[162:163]
    v_pk_mul_f32 v[232:233], v[164:165], v[164:165]
    v_pk_mul_f32 v[234:235], v[166:167], v[166:167]
    v_pk_fma_f32 v[228:229], v[228:229], v[208:209], v[208:209] op_sel:[0,1,0] op_sel_hi:[1,1,0]
    v_pk_fma_f32 v[230:231], v[230:231], v[208:209], v[208:209] op_sel:[0,1,0] op_sel_hi:[1,1,0]
    v_pk_fma_f32 v[232:233], v[232:233], v[208:209], v[208:209] op_sel:[0,1,0] op_sel_hi:[1,1,0]
    v_pk_fma_f32 v[234:235], v[234:235], v[208:209], v[208:209] op_sel:[0,1,0] op_sel_hi:[1,1,0]
    v_pk_mul_f32 v[228:229], v[160:161], v[228:229]
    v_pk_mul_f32 v[230:231], v[162:163], v[230:231]
    v_pk_mul_f32 v[232:233], v[164:165], v[232:233]
    v_pk_mul_f32 v[234:235], v[166:167], v[234:235]
    v_exp_f32 v228, v228
    v_exp_f32 v229, v229
    v_exp_f32 v230, v230
    v_exp_f32 v231, v231
    v_exp_f32 v232, v232
    v_exp_f32 v233, v233
    v_exp_f32 v234, v234
    v_exp_f32 v235, v235
    v_pk_fma_f32 v[228:229], v[228:229], v[210:211], v[210:211] op_sel_hi:[1,0,0]
    v_pk_fma_f32 v[230:231], v[230:231], v[210:211], v[210:211] op_sel_hi:[1,0,0]
    v_pk_fma_f32 v[232:233], v[232:233], v[210:211], v[210:211] op_sel_hi:[1,0,0]
    v_pk_fma_f32 v[234:235], v[234:235], v[210:211], v[210:211] op_sel_hi:[1,0,0]
    v_rcp_f32 v228, v228
    v_rcp_f32 v229, v229
    v_rcp_f32 v230, v230
    v_rcp_f32 v231, v231
    v_rcp_f32 v232, v232
    v_rcp_f32 v233, v233
    v_rcp_f32 v234, v234
    v_rcp_f32 v235, v235
    v_pk_mul_f32 v[228:229], v[160:161], v[228:229]
    v_pk_mul_f32 v[230:231], v[162:163], v[230:231]
    v_pk_mul_f32 v[232:233], v[164:165], v[232:233]
    v_pk_mul_f32 v[234:235], v[166:167], v[234:235]
    v_cvt_pk_bf16_f32 v240, v228, v229
    v_cvt_pk_bf16_f32 v241, v230, v231
    v_cvt_pk_bf16_f32 v242, v232, v233
    v_cvt_pk_bf16_f32 v243, v234, v235
    buffer_store_dwordx4 v[240:243], v22, s[36:39], s88 offen offset:1024 sc1
    s_branch L_s1_done
L_mlp_g1:
    s_waitcnt vmcnt(1)
    s_waitcnt lgkmcnt(0)
    s_barrier
    s_cmp_eq_u32 s64, 4
    s_cbranch_scc0 L_svc17
    s_lshl_b32 s69, s67, 7
    s_add_u32 s69, s69, 9437184
    v_mov_b32 v253, 1
    s_mov_b64 exec, 1
    buffer_atomic_add v253, off, s[36:39], s69 sc1
    s_mov_b64 exec, -1
L_svc17:
    ds_read_b128 v[236:239], v215 offset:0
    v_lshlrev_b32 v228, 16, v213
    v_mov_b32 v206, v213
    s_waitcnt lgkmcnt(0)
    v_add_f32 v224, v236, v237
    v_add_f32 v226, v238, v239
    v_add_f32 v224, v224, v226
    v_cvt_pk_bf16_f32 v204, v224, v224
    v_lshlrev_b32 v225, 16, v204
    v_sub_f32 v225, v224, v225
    v_cvt_pk_bf16_f32 v205, v225, v228
    s_add_u32 s88, s76, 8192
    s_nop 0
    v_mfma_f32_32x32x16_bf16 v[136:151], v[204:207], v[200:203], v[136:151]
    s_nop 11
    v_mul_f32 v228, v136, v136
    v_mul_f32 v229, v137, v137
    v_mul_f32 v230, v138, v138
    v_mul_f32 v231, v139, v139
    v_mul_f32 v232, v140, v140
    v_mul_f32 v233, v141, v141
    v_mul_f32 v234, v142, v142
    v_mul_f32 v235, v143, v143
    v_fma_f32 v228, v228, v209, v208
    v_fma_f32 v229, v229, v209, v208
    v_fma_f32 v230, v230, v209, v208
    v_fma_f32 v231, v231, v209, v208
    v_fma_f32 v232, v232, v209, v208
    s_add_u32 s89, s98, 65536
    s_add_u32 m0, s0, s89
    s_sub_u32 m0, m0, 32768
    s_add_u32 s69, s80, 0xfff4a000
    buffer_load_dwordx4 v249, s[48:51], s69 offen lds
    v_fma_f32 v233, v233, v209, v208
    v_fma_f32 v234, v234, v209, v208
    v_fma_f32 v235, v235, v209, v208
    v_mul_f32 v228, v136, v228
    v_mul_f32 v229, v137, v229
    v_mul_f32 v230, v138, v230
    v_mul_f32 v231, v139, v231
    v_mul_f32 v232, v140, v232
    v_mul_f32 v233, v141, v233
    v_mul_f32 v234, v142, v234
    v_mul_f32 v235, v143, v235
    v_exp_f32 v228, v228
    v_exp_f32 v229, v229
    s_add_u32 s89, s98, 65536
    s_add_u32 m0, s0, s89
    s_add_u32 s69, s80, 0xe000
    buffer_load_dwordx4 v249, s[48:51], s69 offen lds
    v_exp_f32 v230, v230
    v_exp_f32 v231, v231
    v_exp_f32 v232, v232
    v_exp_f32 v233, v233
    v_exp_f32 v234, v234
    v_exp_f32 v235, v235
    v_fma_f32 v228, v228, v210, v210
    v_fma_f32 v229, v229, v210, v210
    v_fma_f32 v230, v230, v210, v210
    v_fma_f32 v231, v231, v210, v210
    v_fma_f32 v232, v232, v210, v210
    v_fma_f32 v233, v233, v210, v210
    v_fma_f32 v234, v234, v210, v210
    s_add_u32 m0, s1, s89
    s_sub_u32 m0, m0, 32768
    s_add_u32 s69, s81, 0xfff4a000
    buffer_load_dwordx4 v249, s[48:51], s69 offen lds
    v_fma_f32 v235, v235, v210, v210
    v_rcp_f32 v228, v228
    v_rcp_f32 v229, v229
    v_rcp_f32 v230, v230
    v_rcp_f32 v231, v231
    v_rcp_f32 v232, v232
    v_rcp_f32 v233, v233
    v_rcp_f32 v234, v234
    v_rcp_f32 v235, v235
    v_mul_f32 v228, v136, v228
    v_mul_f32 v229, v137, v229
    v_mul_f32 v230, v138, v230
    v_mul_f32 v231, v139, v231
    s_add_u32 m0, s1, s89
    s_add_u32 s69, s81, 0xe000
    buffer_load_dwordx4 v249, s[48:51], s69 offen lds
    v_mul_f32 v232, v140, v232
    v_mul_f32 v233, v141, v233
    v_mul_f32 v234, v142, v234
    v_mul_f32 v235, v143, v235
    v_cvt_pk_bf16_f32 v236, v228, v229
    v_cvt_pk_bf16_f32 v237, v230, v231
    v_cvt_pk_bf16_f32 v238, v232, v233
    v_cvt_pk_bf16_f32 v239, v234, v235
    buffer_store_dwordx4 v[236:239], v22, s[36:39], s88 offen offset:0 sc1
    v_mul_f32 v228, v144, v144
    v_mul_f32 v229, v145, v145
    v_mul_f32 v230, v146, v146
    v_mul_f32 v231, v147, v147
    s_add_u32 m0, s3, s89
    s_sub_u32 m0, m0, 32768
    s_add_u32 s69, s82, 0xfff4a000
    buffer_load_dwordx4 v249, s[48:51], s69 offen lds
    v_mul_f32 v232, v148, v148
    v_mul_f32 v233, v149, v149
    v_mul_f32 v234, v150, v150
    v_mul_f32 v235, v151, v151
    v_fma_f32 v228, v228, v209, v208
    v_fma_f32 v229, v229, v209, v208
    s_waitcnt vmcnt(6)
    v_mov_b32 v218, 161792
    v_mov_b32 v219, 1
    s_mov_b64 exec, 1
    ds_add_rtn_u32 v219, v218, v219
    s_mov_b64 exec, -1
    v_fma_f32 v230, v230, v209, v208
    v_fma_f32 v231, v231, v209, v208
    v_fma_f32 v232, v232, v209, v208
    v_fma_f32 v233, v233, v209, v208
    v_fma_f32 v234, v234, v209, v208
    v_fma_f32 v235, v235, v209, v208
    v_mul_f32 v228, v144, v228
    s_add_u32 m0, s3, s89
    s_add_u32 s69, s82, 0xe000
    buffer_load_dwordx4 v249, s[48:51], s69 offen lds
    v_mul_f32 v229, v145, v229
    v_mul_f32 v230, v146, v230
    v_mul_f32 v231, v147, v231
    s_waitcnt lgkmcnt(0)
    v_readfirstlane_b32 s69, v219
    s_nop 0
    s_cmp_eq_u32 s69, 7
    s_cbranch_scc0 L_ar18
    s_lshl_b32 s69, s67, 7
    s_add_u32 s69, s69, 9441280
    v_mov_b32 v253, 1
    s_mov_b64 exec, 1
    buffer_atomic_add v253, off, s[36:39], s69 sc1
    s_mov_b64 exec, -1
L_ar18:
    v_mul_f32 v232, v148, v232
    v_mul_f32 v233, v149, v233
    v_mul_f32 v234, v150, v234
    v_mul_f32 v235, v151, v235
    v_exp_f32 v228, v228
    v_exp_f32 v229, v229
    v_exp_f32 v230, v230
    v_exp_f32 v231, v231
    v_exp_f32 v232, v232
    v_exp_f32 v233, v233
    s_add_u32 m0, s13, s89
    s_sub_u32 m0, m0, 32768
    s_add_u32 s69, s83, 0xfff4a000
    buffer_load_dwordx4 v249, s[48:51], s69 offen lds
    v_exp_f32 v234, v234
    v_exp_f32 v235, v235
    v_fma_f32 v228, v228, v210, v210
    v_fma_f32 v229, v229, v210, v210
    v_fma_f32 v230, v230, v210, v210
    v_fma_f32 v231, v231, v210, v210
    v_fma_f32 v232, v232, v210, v210
    v_fma_f32 v233, v233, v210, v210
    v_fma_f32 v234, v234, v210, v210
    v_fma_f32 v235, v235, v210, v210
    v_rcp_f32 v228, v228
    v_rcp_f32 v229, v229
    v_rcp_f32 v230, v230
    s_add_u32 m0, s13, s89
    s_add_u32 s69, s83, 0xe000
    buffer_load_dwordx4 v249, s[48:51], s69 offen lds
    v_rcp_f32 v231, v231
    v_rcp_f32 v232, v232
    v_rcp_f32 v233, v233
    v_rcp_f32 v234, v234
    v_rcp_f32 v235, v235
    v_mul_f32 v228, v144, v228
    v_mul_f32 v229, v145, v229
    v_mul_f32 v230, v146, v230
    v_mul_f32 v231, v147, v231
    v_mul_f32 v232, v148, v232
    v_mul_f32 v233, v149, v233
    v_mul_f32 v234, v150, v234
    v_mul_f32 v235, v151, v235
    v_cvt_pk_bf16_f32 v240, v228, v229
    v_cvt_pk_bf16_f32 v241, v230, v231
    v_cvt_pk_bf16_f32 v242, v232, v233
    v_cvt_pk_bf16_f32 v243, v234, v235
    buffer_store_dwordx4 v[240:243], v22, s[36:39], s88 offen offset:1024 sc1
    s_add_u32 m0, s14, s89
    s_sub_u32 m0, m0, 32768
    s_add_u32 s69, s84, 0xfff4a000
    buffer_load_dwordx4 v249, s[48:51], s69 offen lds
    s_add_u32 m0, s14, s89
    s_add_u32 s69, s84, 0xe000
    buffer_load_dwordx4 v249, s[48:51], s69 offen lds
    s_add_u32 m0, s15, s89
    s_sub_u32 m0, m0, 32768
    s_add_u32 s69, s85, 0xfff4a000
    buffer_load_dwordx4 v249, s[48:51], s69 offen lds
    s_add_u32 m0, s15, s89
    s_add_u32 s69, s85, 0xe000
    buffer_load_dwordx4 v249, s[48:51], s69 offen lds
    s_add_u32 m0, s22, s89
    s_sub_u32 m0, m0, 32768
    s_add_u32 s69, s86, 0xfff4a000
    buffer_load_dwordx4 v249, s[48:51], s69 offen lds
    s_add_u32 m0, s22, s89
    s_add_u32 s69, s86, 0xe000
    buffer_load_dwordx4 v249, s[48:51], s69 offen lds
    s_add_u32 m0, s23, s89
    s_sub_u32 m0, m0, 32768
    s_add_u32 s69, s87, 0xfff4a000
    buffer_load_dwordx4 v249, s[48:51], s69 offen lds
    s_add_u32 m0, s23, s89
    s_add_u32 s69, s87, 0xe000
    buffer_load_dwordx4 v249, s[48:51], s69 offen lds
    s_waitcnt lgkmcnt(0)
    s_cmp_eq_u32 s64, 4
    s_cbranch_scc0 L_svc19
    v_mov_b32 v252, 0
    buffer_load_dword v252, off, s[36:39], s92 sc1
L_svc19:
    s_branch L_s1_done
L_att_body:
    s_waitcnt vmcnt(5)
    s_barrier
    ds_read_b128 v[148:151], v6
    ds_read_b64_tr_b16 v[152:153], v10 offset:0
    ds_read_b64_tr_b16 v[154:155], v10 offset:512
    ds_read_b64_tr_b16 v[156:157], v10 offset:8192
    ds_read_b64_tr_b16 v[158:159], v10 offset:8704
    ds_read_b64_tr_b16 v[160:161], v10 offset:16384
    ds_read_b64_tr_b16 v[162:163], v10 offset:16896
    v_add_u32 v6, 0xfffec000, v6
    v_add_u32 v10, 0xfffec000, v10
    ds_read_b128 v[164:167], v7
    ds_read_b64_tr_b16 v[168:169], v11 offset:0
    ds_read_b64_tr_b16 v[170:171], v11 offset:512
    ds_read_b64_tr_b16 v[172:173], v11 offset:8192
    ds_read_b64_tr_b16 v[174:175], v11 offset:8704
    ds_read_b64_tr_b16 v[176:177], v11 offset:16384
    ds_read_b64_tr_b16 v[178:179], v11 offset:16896
    ds_read_b128 v[136:139], v14 offset:0
    v_add_u32 v7, 0xfffec000, v7
    v_add_u32 v11, 0xfffec000, v11
    s_add_u32 m0, s72, 40960
    s_nop 0
    buffer_load_dwordx4 v2, s[28:31], s6 offen lds
    s_add_u32 m0, s72, 41984
    s_nop 0
    buffer_load_dwordx4 v3, s[28:31], s6 offen lds
    s_add_u32 m0, s73, 57344
    s_mul_i32 s89, s6, 1344
    s_add_u32 s89, s89, s77
    buffer_load_dwordx4 v4, s[32:35], s89 offen offset:0 lds
    s_add_u32 m0, s73, 64640
    s_nop 0
    buffer_load_dwordx4 v4, s[32:35], s89 offen offset:896 lds
    s_add_u32 m0, s73, 71936
    s_nop 0
    buffer_load_dwordx4 v4, s[32:35], s89 offen offset:1792 lds
    s_waitcnt lgkmcnt(8)
    v_mfma_f32_32x32x16_bf16 v[24:39], v[152:155], v[148:151], 0
    ds_read_b128 v[180:183], v8
    ds_read_b64_tr_b16 v[184:185], v12 offset:0
    ds_read_b64_tr_b16 v[186:187], v12 offset:512
    v_mfma_f32_32x32x16_bf16 v[40:55], v[156:159], v[148:151], 0
    ds_read_b64_tr_b16 v[188:189], v12 offset:8192
    ds_read_b64_tr_b16 v[190:191], v12 offset:8704
    ds_read_b64_tr_b16 v[192:193], v12 offset:16384
    v_mfma_f32_32x32x16_bf16 v[56:71], v[148:151], v[160:163], 0
    ds_read_b64_tr_b16 v[194:195], v12 offset:16896
    v_add_u32 v8, 0xfffec000, v8
    v_add_u32 v12, 0xfffec000, v12
    s_waitcnt lgkmcnt(7)
    v_mfma_f32_32x32x16_bf16 v[24:39], v[168:171], v[164:167], v[24:39]
    ds_read_b128 v[196:199], v9
    ds_read_b64_tr_b16 v[200:201], v13 offset:0
    ds_read_b64_tr_b16 v[202:203], v13 offset:512
    v_and_b32 v140, v128, v136
    v_and_b32 v141, v128, v137
    v_and_b32 v142, v128, v138
    v_and_b32 v143, v128, v139
    v_and_b32 v144, v129, v136
    v_and_b32 v145, v129, v137
    v_and_b32 v146, v129, v138
    v_and_b32 v147, v129, v139
    v_mfma_f32_32x32x16_bf16 v[40:55], v[172:175], v[164:167], v[40:55]
    ds_read_b64_tr_b16 v[204:205], v13 offset:8192
    ds_read_b64_tr_b16 v[206:207], v13 offset:8704
    ds_read_b64_tr_b16 v[208:209], v13 offset:16384
    v_mfma_f32_16x16x32_bf16 v[72:75], v[172:175], v[140:143], 0
    v_mfma_f32_16x16x32_bf16 v[76:79], v[172:175], v[144:147], 0
    v_mfma_f32_32x32x16_bf16 v[56:71], v[164:167], v[176:179], v[56:71]
    ds_read_b64_tr_b16 v[210:211], v13 offset:16896
    v_add_u32 v9, 0xfffec000, v9
    v_add_u32 v13, 0xfffec000, v13
    v_mfma_f32_16x16x32_bf16 v[80:83], v[140:143], v[176:179], 0
    v_mfma_f32_16x16x32_bf16 v[84:87], v[144:147], v[176:179], 0
    s_waitcnt vmcnt(5)
    s_waitcnt lgkmcnt(0)
    s_barrier
    v_mfma_f32_32x32x16_bf16 v[24:39], v[184:187], v[180:183], v[24:39]
    s_cmp_eq_u32 s75, 0
    s_cbranch_scc0 L_site20
    s_add_u32 m0, s72, 81920
    s_nop 0
    buffer_load_dwordx4 v2, s[28:31], s7 offen lds
    s_add_u32 m0, s72, 82944
    s_nop 0
    buffer_load_dwordx4 v3, s[28:31], s7 offen lds
    s_add_u32 m0, s73, 98304
    s_mul_i32 s89, s7, 1344
    s_add_u32 s89, s89, s77
    buffer_load_dwordx4 v4, s[32:35], s89 offen offset:0 lds
    s_add_u32 m0, s73, 105600
    s_nop 0
    buffer_load_dwordx4 v4, s[32:35], s89 offen offset:896 lds
    s_add_u32 m0, s73, 112896
    s_nop 0
    buffer_load_dwordx4 v4, s[32:35], s89 offen offset:1792 lds
L_site20:
    ds_read_b128 v[148:151], v6
    ds_read_b64_tr_b16 v[152:153], v10 offset:0
    ds_read_b64_tr_b16 v[154:155], v10 offset:512
    v_mfma_f32_32x32x16_bf16 v[40:55], v[188:191], v[180:183], v[40:55]
    ds_read_b64_tr_b16 v[156:157], v10 offset:8192
    ds_read_b64_tr_b16 v[158:159], v10 offset:8704
    ds_read_b64_tr_b16 v[160:161], v10 offset:16384
    v_mfma_f32_32x32x16_bf16 v[56:71], v[180:183], v[192:195], v[56:71]
    ds_read_b64_tr_b16 v[162:163], v10 offset:16896
    v_add_u32 v6, 0xa000, v6
    v_add_u32 v10, 0xa000, v10
    v_mfma_f32_32x32x16_bf16 v[24:39], v[200:203], v[196:199], v[24:39]
    ds_read_b128 v[164:167], v7
    ds_read_b64_tr_b16 v[168:169], v11 offset:0
    ds_read_b64_tr_b16 v[170:171], v11 offset:512
    v_mfma_f32_16x16x32_bf16 v[88:91], v[100:103], v[200:203], 0
    v_mfma_f32_32x32x16_bf16 v[40:55], v[204:207], v[196:199], v[40:55]
    ds_read_b64_tr_b16 v[172:173], v11 offset:8192
    ds_read_b64_tr_b16 v[174:175], v11 offset:8704
    ds_read_b64_tr_b16 v[176:177], v11 offset:16384
    v_mfma_f32_16x16x32_bf16 v[92:95], v[100:103], v[204:207], 0
    v_mfma_f32_32x32x16_bf16 v[56:71], v[196:199], v[208:211], v[56:71]
    ds_read_b64_tr_b16 v[178:179], v11 offset:16896
    ds_read_b128 v[136:139], v14 offset:2048
    v_add_u32 v7, 0xa000, v7
    v_add_u32 v11, 0xa000, v11
    v_mfma_f32_16x16x32_bf16 v[96:99], v[100:103], v[208:211], 0
    s_cmp_eq_u32 s75, 1
    s_cbranch_scc0 L_site21
    s_add_u32 m0, s72, 81920
    s_nop 0
    buffer_load_dwordx4 v2, s[28:31], s7 offen lds
    s_add_u32 m0, s72, 82944
    s_nop 0
    buffer_load_dwordx4 v3, s[28:31], s7 offen lds
    s_add_u32 m0, s73, 98304
    s_mul_i32 s89, s7, 1344
    s_add_u32 s89, s89, s77
    buffer_load_dwordx4 v4, s[32:35], s89 offen offset:0 lds
    s_add_u32 m0, s73, 105600
    s_nop 0
    buffer_load_dwordx4 v4, s[32:35], s89 offen offset:896 lds
    s_add_u32 m0, s73, 112896
    s_nop 0
    buffer_load_dwordx4 v4, s[32:35], s89 offen offset:1792 lds
L_site21:
    s_waitcnt lgkmcnt(8)
    v_mfma_f32_32x32x16_bf16 v[24:39], v[152:155], v[148:151], v[24:39]
    ds_read_b128 v[180:183], v8
    ds_read_b64_tr_b16 v[184:185], v12 offset:0
    ds_read_b64_tr_b16 v[186:187], v12 offset:512
    v_mfma_f32_32x32x16_bf16 v[40:55], v[156:159], v[148:151], v[40:55]
    ds_read_b64_tr_b16 v[188:189], v12 offset:8192
    ds_read_b64_tr_b16 v[190:191], v12 offset:8704
    ds_read_b64_tr_b16 v[192:193], v12 offset:16384
    v_mfma_f32_32x32x16_bf16 v[56:71], v[148:151], v[160:163], v[56:71]
    ds_read_b64_tr_b16 v[194:195], v12 offset:16896
    v_add_u32 v8, 0xa000, v8
    v_add_u32 v12, 0xa000, v12
    s_waitcnt lgkmcnt(7)
    v_mfma_f32_32x32x16_bf16 v[24:39], v[168:171], v[164:167], v[24:39]
    ds_read_b128 v[196:199], v9
    ds_read_b64_tr_b16 v[200:201], v13 offset:0
    ds_read_b64_tr_b16 v[202:203], v13 offset:512
    v_and_b32 v140, v128, v136
    v_and_b32 v141, v128, v137
    v_and_b32 v142, v128, v138
    v_and_b32 v143, v128, v139
    v_and_b32 v144, v129, v136
    v_and_b32 v145, v129, v137
    v_and_b32 v146, v129, v138
    v_and_b32 v147, v129, v139
    v_mfma_f32_32x32x16_bf16 v[40:55], v[172:175], v[164:167], v[40:55]
    ds_read_b64_tr_b16 v[204:205], v13 offset:8192
    ds_read_b64_tr_b16 v[206:207], v13 offset:8704
    ds_read_b64_tr_b16 v[208:209], v13 offset:16384
    v_mfma_f32_16x16x32_bf16 v[72:75], v[172:175], v[140:143], v[72:75]
    v_mfma_f32_16x16x32_bf16 v[76:79], v[172:175], v[144:147], v[76:79]
    v_mfma_f32_32x32x16_bf16 v[56:71], v[164:167], v[176:179], v[56:71]
    ds_read_b64_tr_b16 v[210:211], v13 offset:16896
    v_add_u32 v9, 0xa000, v9
    v_add_u32 v13, 0xa000, v13
    v_mfma_f32_16x16x32_bf16 v[80:83], v[140:143], v[176:179], v[80:83]
    v_mfma_f32_16x16x32_bf16 v[84:87], v[144:147], v[176:179], v[84:87]
    s_waitcnt vmcnt(5)
    s_waitcnt lgkmcnt(0)
    s_barrier
    v_mfma_f32_32x32x16_bf16 v[24:39], v[184:187], v[180:183], v[24:39]
    s_cmp_eq_u32 s75, 0
    s_cbranch_scc0 L_site22
    s_add_u32 m0, s72, 0
    s_nop 0
    buffer_load_dwordx4 v2, s[28:31], s10 offen lds
    s_add_u32 m0, s72, 1024
    s_nop 0
    buffer_load_dwordx4 v3, s[28:31], s10 offen lds
    s_add_u32 m0, s73, 16384
    s_mul_i32 s89, s10, 1344
    s_add_u32 s89, s89, s77
    buffer_load_dwordx4 v4, s[32:35], s89 offen offset:0 lds
    s_add_u32 m0, s73, 23680
    s_nop 0
    buffer_load_dwordx4 v4, s[32:35], s89 offen offset:896 lds
    s_add_u32 m0, s73, 30976
    s_nop 0
    buffer_load_dwordx4 v4, s[32:35], s89 offen offset:1792 lds
    s_lshl_b32 s69, s2, 3
    s_add_u32 s69, s69, s64
    s_lshl_b32 s70, s69, 10
    s_mov_b32 s48, s16
    s_mov_b32 s49, s17
    s_mov_b32 s50, 1605632
    s_mov_b32 s51, 0x20000
    s_cmp_lt_u32 s69, 1568
    s_cbranch_scc1 L_pf23
    s_mov_b32 s48, s8
    s_mov_b32 s49, s9
    s_mov_b32 s50, 401408
    s_sub_u32 s70, s70, 1605632
L_pf23:
    s_mov_b64 exec, 0xff
    buffer_load_dword v250, v23, s[48:51], s70 offen
    s_mov_b64 exec, -1
L_site22:
    ds_read_b128 v[148:151], v6
    ds_read_b64_tr_b16 v[152:153], v10 offset:0
    ds_read_b64_tr_b16 v[154:155], v10 offset:512
    v_mfma_f32_32x32x16_bf16 v[40:55], v[188:191], v[180:183], v[40:55]
    ds_read_b64_tr_b16 v[156:157], v10 offset:8192
    ds_read_b64_tr_b16 v[158:159], v10 offset:8704
    ds_read_b64_tr_b16 v[160:161], v10 offset:16384
    v_mfma_f32_32x32x16_bf16 v[56:71], v[180:183], v[192:195], v[56:71]
    ds_read_b64_tr_b16 v[162:163], v10 offset:16896
    v_add_u32 v6, 0xa000, v6
    v_add_u32 v10, 0xa000, v10
    v_mfma_f32_32x32x16_bf16 v[24:39], v[200:203], v[196:199], v[24:39]
    ds_read_b128 v[164:167], v7
    ds_read_b64_tr_b16 v[168:169], v11 offset:0
    ds_read_b64_tr_b16 v[170:171], v11 offset:512
    v_mfma_f32_16x16x32_bf16 v[88:91], v[100:103], v[200:203], v[88:91]
    v_mfma_f32_32x32x16_bf16 v[40:55], v[204:207], v[196:199], v[40:55]
    ds_read_b64_tr_b16 v[172:173], v11 offset:8192
    ds_read_b64_tr_b16 v[174:175], v11 offset:8704
    ds_read_b64_tr_b16 v[176:177], v11 offset:16384
    v_mfma_f32_16x16x32_bf16 v[92:95], v[100:103], v[204:207], v[92:95]
    v_mfma_f32_32x32x16_bf16 v[56:71], v[196:199], v[208:211], v[56:71]
    ds_read_b64_tr_b16 v[178:179], v11 offset:16896
    ds_read_b128 v[136:139], v14 offset:4096
    v_add_u32 v7, 0xa000, v7
    v_add_u32 v11, 0xa000, v11
    v_mfma_f32_16x16x32_bf16 v[96:99], v[100:103], v[208:211], v[96:99]
    s_cmp_eq_u32 s75, 1
    s_cbranch_scc0 L_site24
    s_add_u32 m0, s72, 0
    s_nop 0
    buffer_load_dwordx4 v2, s[28:31], s10 offen lds
    s_add_u32 m0, s72, 1024
    s_nop 0
    buffer_load_dwordx4 v3, s[28:31], s10 offen lds
    s_add_u32 m0, s73, 16384
    s_mul_i32 s89, s10, 1344
    s_add_u32 s89, s89, s77
    buffer_load_dwordx4 v4, s[32:35], s89 offen offset:0 lds
    s_add_u32 m0, s73, 23680
    s_nop 0
    buffer_load_dwordx4 v4, s[32:35], s89 offen offset:896 lds
    s_add_u32 m0, s73, 30976
    s_nop 0
    buffer_load_dwordx4 v4, s[32:35], s89 offen offset:1792 lds
    s_lshl_b32 s69, s2, 3
    s_add_u32 s69, s69, s64
    s_lshl_b32 s70, s69, 10
    s_mov_b32 s48, s16
    s_mov_b32 s49, s17
    s_mov_b32 s50, 1605632
    s_mov_b32 s51, 0x20000
    s_cmp_lt_u32 s69, 1568
    s_cbranch_scc1 L_pf25
    s_mov_b32 s48, s8
    s_mov_b32 s49, s9
    s_mov_b32 s50, 401408
    s_sub_u32 s70, s70, 1605632
L_pf25:
    s_mov_b64 exec, 0xff
    buffer_load_dword v250, v23, s[48:51], s70 offen
    s_mov_b64 exec, -1
L_site24:
    s_waitcnt lgkmcnt(8)
    v_mfma_f32_32x32x16_bf16 v[24:39], v[152:155], v[148:151], v[24:39]
    ds_read_b128 v[180:183], v8
    ds_read_b64_tr_b16 v[184:185], v12 offset:0
    ds_read_b64_tr_b16 v[186:187], v12 offset:512
    v_mfma_f32_32x32x16_bf16 v[40:55], v[156:159], v[148:151], v[40:55]
    ds_read_b64_tr_b16 v[188:189], v12 offset:8192
    ds_read_b64_tr_b16 v[190:191], v12 offset:8704
    ds_read_b64_tr_b16 v[192:193], v12 offset:16384
    v_mfma_f32_32x32x16_bf16 v[56:71], v[148:151], v[160:163], v[56:71]
    ds_read_b64_tr_b16 v[194:195], v12 offset:16896
    v_add_u32 v8, 0xa000, v8
    v_add_u32 v12, 0xa000, v12
    s_waitcnt lgkmcnt(7)
    v_mfma_f32_32x32x16_bf16 v[24:39], v[168:171], v[164:167], v[24:39]
    ds_read_b128 v[196:199], v9
    ds_read_b64_tr_b16 v[200:201], v13 offset:0
    ds_read_b64_tr_b16 v[202:203], v13 offset:512
    v_and_b32 v140, v128, v136
    v_and_b32 v141, v128, v137
    v_and_b32 v142, v128, v138
    v_and_b32 v143, v128, v139
    v_and_b32 v144, v129, v136
    v_and_b32 v145, v129, v137
    v_and_b32 v146, v129, v138
    v_and_b32 v147, v129, v139
    v_mfma_f32_32x32x16_bf16 v[40:55], v[172:175], v[164:167], v[40:55]
    ds_read_b64_tr_b16 v[204:205], v13 offset:8192
    ds_read_b64_tr_b16 v[206:207], v13 offset:8704
    ds_read_b64_tr_b16 v[208:209], v13 offset:16384
    v_mfma_f32_16x16x32_bf16 v[72:75], v[172:175], v[140:143], v[72:75]
    v_mfma_f32_16x16x32_bf16 v[76:79], v[172:175], v[144:147], v[76:79]
    v_mfma_f32_32x32x16_bf16 v[56:71], v[164:167], v[176:179], v[56:71]
    ds_read_b64_tr_b16 v[210:211], v13 offset:16896
    v_add_u32 v9, 0xa000, v9
    v_add_u32 v13, 0xa000, v13
    v_mfma_f32_16x16x32_bf16 v[80:83], v[140:143], v[176:179], v[80:83]
    v_mfma_f32_16x16x32_bf16 v[84:87], v[144:147], v[176:179], v[84:87]
    s_waitcnt vmcnt(6)
    s_waitcnt lgkmcnt(0)
    s_barrier
    s_cmp_eq_u32 s64, 4
    s_cbranch_scc0 L_svc26
    v_mov_b32 v253, 0
    buffer_load_dword v253, off, s[60:63], 0 sc1
L_svc26:
    v_mfma_f32_32x32x16_bf16 v[24:39], v[184:187], v[180:183], v[24:39]
    s_cmp_eq_u32 s75, 0
    s_cbranch_scc0 L_site27
    s_add_u32 m0, s72, 40960
    s_nop 0
    buffer_load_dwordx4 v2, s[28:31], s11 offen lds
    s_add_u32 m0, s72, 41984
    s_nop 0
    buffer_load_dwordx4 v3, s[28:31], s11 offen lds
    s_add_u32 m0, s73, 57344
    s_mul_i32 s89, s11, 1344
    s_add_u32 s89, s89, s77
    buffer_load_dwordx4 v4, s[32:35], s89 offen offset:0 lds
    s_add_u32 m0, s73, 64640
    s_nop 0
    buffer_load_dwordx4 v4, s[32:35], s89 offen offset:896 lds
    s_add_u32 m0, s73, 71936
    s_nop 0
    buffer_load_dwordx4 v4, s[32:35], s89 offen offset:1792 lds
L_site27:
    ds_read_b128 v[148:151], v6
    ds_read_b64_tr_b16 v[152:153], v10 offset:0
    ds_read_b64_tr_b16 v[154:155], v10 offset:512
    v_mfma_f32_32x32x16_bf16 v[40:55], v[188:191], v[180:183], v[40:55]
    ds_read_b64_tr_b16 v[156:157], v10 offset:8192
    ds_read_b64_tr_b16 v[158:159], v10 offset:8704
    ds_read_b64_tr_b16 v[160:161], v10 offset:16384
    v_mfma_f32_32x32x16_bf16 v[56:71], v[180:183], v[192:195], v[56:71]
    ds_read_b64_tr_b16 v[162:163], v10 offset:16896
    v_add_u32 v6, 0xfffec000, v6
    v_add_u32 v10, 0xfffec000, v10
    v_mfma_f32_32x32x16_bf16 v[24:39], v[200:203], v[196:199], v[24:39]
    ds_read_b128 v[164:167], v7
    ds_read_b64_tr_b16 v[168:169], v11 offset:0
    ds_read_b64_tr_b16 v[170:171], v11 offset:512
    v_mfma_f32_16x16x32_bf16 v[88:91], v[100:103], v[200:203], v[88:91]
    v_mfma_f32_32x32x16_bf16 v[40:55], v[204:207], v[196:199], v[40:55]
    ds_read_b64_tr_b16 v[172:173], v11 offset:8192
    ds_read_b64_tr_b16 v[174:175], v11 offset:8704
    ds_read_b64_tr_b16 v[176:177], v11 offset:16384
    v_mfma_f32_16x16x32_bf16 v[92:95], v[100:103], v[204:207], v[92:95]
    v_mfma_f32_32x32x16_bf16 v[56:71], v[196:199], v[208:211], v[56:71]
    ds_read_b64_tr_b16 v[178:179], v11 offset:16896
    ds_read_b128 v[136:139], v14 offset:6144
    v_add_u32 v7, 0xfffec000, v7
    v_add_u32 v11, 0xfffec000, v11
    v_mfma_f32_16x16x32_bf16 v[96:99], v[100:103], v[208:211], v[96:99]
    s_cmp_eq_u32 s75, 1
    s_cbranch_scc0 L_site28
    s_add_u32 m0, s72, 40960
    s_nop 0
    buffer_load_dwordx4 v2, s[28:31], s11 offen lds
    s_add_u32 m0, s72, 41984
    s_nop 0
    buffer_load_dwordx4 v3, s[28:31], s11 offen lds
    s_add_u32 m0, s73, 57344
    s_mul_i32 s89, s11, 1344
    s_add_u32 s89, s89, s77
    buffer_load_dwordx4 v4, s[32:35], s89 offen offset:0 lds
    s_add_u32 m0, s73, 64640
    s_nop 0
    buffer_load_dwordx4 v4, s[32:35], s89 offen offset:896 lds
    s_add_u32 m0, s73, 71936
    s_nop 0
    buffer_load_dwordx4 v4, s[32:35], s89 offen offset:1792 lds
L_site28:
    s_waitcnt lgkmcnt(8)
    v_mfma_f32_32x32x16_bf16 v[24:39], v[152:155], v[148:151], v[24:39]
    ds_read_b128 v[180:183], v8
    ds_read_b64_tr_b16 v[184:185], v12 offset:0
    ds_read_b64_tr_b16 v[186:187], v12 offset:512
    v_mfma_f32_32x32x16_bf16 v[40:55], v[156:159], v[148:151], v[40:55]
    ds_read_b64_tr_b16 v[188:189], v12 offset:8192
    ds_read_b64_tr_b16 v[190:191], v12 offset:8704
    ds_read_b64_tr_b16 v[192:193], v12 offset:16384
    v_mfma_f32_32x32x16_bf16 v[56:71], v[148:151], v[160:163], v[56:71]
    ds_read_b64_tr_b16 v[194:195], v12 offset:16896
    v_add_u32 v8, 0xfffec000, v8
    v_add_u32 v12, 0xfffec000, v12
    s_waitcnt lgkmcnt(7)
    v_mfma_f32_32x32x16_bf16 v[24:39], v[168:171], v[164:167], v[24:39]
    ds_read_b128 v[196:199], v9
    ds_read_b64_tr_b16 v[200:201], v13 offset:0
    ds_read_b64_tr_b16 v[202:203], v13 offset:512
    v_and_b32 v140, v128, v136
    v_and_b32 v141, v128, v137
    v_and_b32 v142, v128, v138
    v_and_b32 v143, v128, v139
    v_and_b32 v144, v129, v136
    v_and_b32 v145, v129, v137
    v_and_b32 v146, v129, v138
    v_and_b32 v147, v129, v139
    v_mfma_f32_32x32x16_bf16 v[40:55], v[172:175], v[164:167], v[40:55]
    ds_read_b64_tr_b16 v[204:205], v13 offset:8192
    ds_read_b64_tr_b16 v[206:207], v13 offset:8704
    ds_read_b64_tr_b16 v[208:209], v13 offset:16384
    v_mfma_f32_16x16x32_bf16 v[72:75], v[172:175], v[140:143], v[72:75]
    v_mfma_f32_16x16x32_bf16 v[76:79], v[172:175], v[144:147], v[76:79]
    v_mfma_f32_32x32x16_bf16 v[56:71], v[164:167], v[176:179], v[56:71]
    ds_read_b64_tr_b16 v[210:211], v13 offset:16896
    v_add_u32 v9, 0xfffec000, v9
    v_add_u32 v13, 0xfffec000, v13
    v_mfma_f32_16x16x32_bf16 v[80:83], v[140:143], v[176:179], v[80:83]
    v_mfma_f32_16x16x32_bf16 v[84:87], v[144:147], v[176:179], v[84:87]
    s_waitcnt vmcnt(6)
    s_waitcnt lgkmcnt(0)
    s_barrier
    v_mfma_f32_32x32x16_bf16 v[24:39], v[184:187], v[180:183], v[24:39]
    s_cmp_eq_u32 s75, 0
    s_cbranch_scc0 L_site29
    s_add_u32 m0, s72, 81920
    s_nop 0
    buffer_load_dwordx4 v2, s[28:31], s12 offen lds
    s_add_u32 m0, s72, 82944
    s_nop 0
    buffer_load_dwordx4 v3, s[28:31], s12 offen lds
    s_add_u32 m0, s73, 98304
    s_mul_i32 s89, s12, 1344
    s_add_u32 s89, s89, s77
    buffer_load_dwordx4 v4, s[32:35], s89 offen offset:0 lds
    s_add_u32 m0, s73, 105600
    s_nop 0
    buffer_load_dwordx4 v4, s[32:35], s89 offen offset:896 lds
    s_add_u32 m0, s73, 112896
    s_nop 0
    buffer_load_dwordx4 v4, s[32:35], s89 offen offset:1792 lds
L_site29:
    ds_read_b128 v[148:151], v6
    ds_read_b64_tr_b16 v[152:153], v10 offset:0
    ds_read_b64_tr_b16 v[154:155], v10 offset:512
    v_mfma_f32_32x32x16_bf16 v[40:55], v[188:191], v[180:183], v[40:55]
    ds_read_b64_tr_b16 v[156:157], v10 offset:8192
    ds_read_b64_tr_b16 v[158:159], v10 offset:8704
    ds_read_b64_tr_b16 v[160:161], v10 offset:16384
    v_mfma_f32_32x32x16_bf16 v[56:71], v[180:183], v[192:195], v[56:71]
    ds_read_b64_tr_b16 v[162:163], v10 offset:16896
    v_add_u32 v6, 0xa000, v6
    v_add_u32 v10, 0xa000, v10
    v_mfma_f32_32x32x16_bf16 v[24:39], v[200:203], v[196:199], v[24:39]
    ds_read_b128 v[164:167], v7
    ds_read_b64_tr_b16 v[168:169], v11 offset:0
    ds_read_b64_tr_b16 v[170:171], v11 offset:512
    v_mfma_f32_16x16x32_bf16 v[88:91], v[100:103], v[200:203], v[88:91]
    v_mfma_f32_32x32x16_bf16 v[40:55], v[204:207], v[196:199], v[40:55]
    ds_read_b64_tr_b16 v[172:173], v11 offset:8192
    ds_read_b64_tr_b16 v[174:175], v11 offset:8704
    ds_read_b64_tr_b16 v[176:177], v11 offset:16384
    v_mfma_f32_16x16x32_bf16 v[92:95], v[100:103], v[204:207], v[92:95]
    v_mfma_f32_32x32x16_bf16 v[56:71], v[196:199], v[208:211], v[56:71]
    ds_read_b64_tr_b16 v[178:179], v11 offset:16896
    ds_read_b128 v[136:139], v14 offset:8192
    v_add_u32 v7, 0xa000, v7
    v_add_u32 v11, 0xa000, v11
    v_mfma_f32_16x16x32_bf16 v[96:99], v[100:103], v[208:211], v[96:99]
    s_cmp_eq_u32 s75, 1
    s_cbranch_scc0 L_site30
    s_add_u32 m0, s72, 81920
    s_nop 0
    buffer_load_dwordx4 v2, s[28:31], s12 offen lds
    s_add_u32 m0, s72, 82944
    s_nop 0
    buffer_load_dwordx4 v3, s[28:31], s12 offen lds
    s_add_u32 m0, s73, 98304
    s_mul_i32 s89, s12, 1344
    s_add_u32 s89, s89, s77
    buffer_load_dwordx4 v4, s[32:35], s89 offen offset:0 lds
    s_add_u32 m0, s73, 105600
    s_nop 0
    buffer_load_dwordx4 v4, s[32:35], s89 offen offset:896 lds
    s_add_u32 m0, s73, 112896
    s_nop 0
    buffer_load_dwordx4 v4, s[32:35], s89 offen offset:1792 lds
L_site30:
    s_waitcnt lgkmcnt(8)
    v_mfma_f32_32x32x16_bf16 v[24:39], v[152:155], v[148:151], v[24:39]
    ds_read_b128 v[180:183], v8
    ds_read_b64_tr_b16 v[184:185], v12 offset:0
    ds_read_b64_tr_b16 v[186:187], v12 offset:512
    v_mfma_f32_32x32x16_bf16 v[40:55], v[156:159], v[148:151], v[40:55]
    ds_read_b64_tr_b16 v[188:189], v12 offset:8192
    ds_read_b64_tr_b16 v[190:191], v12 offset:8704
    ds_read_b64_tr_b16 v[192:193], v12 offset:16384
    v_mfma_f32_32x32x16_bf16 v[56:71], v[148:151], v[160:163], v[56:71]
    ds_read_b64_tr_b16 v[194:195], v12 offset:16896
    v_add_u32 v8, 0xa000, v8
    v_add_u32 v12, 0xa000, v12
    s_waitcnt lgkmcnt(7)
    v_mfma_f32_32x32x16_bf16 v[24:39], v[168:171], v[164:167], v[24:39]
    ds_read_b128 v[196:199], v9
    ds_read_b64_tr_b16 v[200:201], v13 offset:0
    ds_read_b64_tr_b16 v[202:203], v13 offset:512
    v_and_b32 v140, v128, v136
    v_and_b32 v141, v128, v137
    v_and_b32 v142, v128, v138
    v_and_b32 v143, v128, v139
    v_and_b32 v144, v129, v136
    v_and_b32 v145, v129, v137
    v_and_b32 v146, v129, v138
    v_and_b32 v147, v129, v139
    v_mfma_f32_32x32x16_bf16 v[40:55], v[172:175], v[164:167], v[40:55]
    ds_read_b64_tr_b16 v[204:205], v13 offset:8192
    ds_read_b64_tr_b16 v[206:207], v13 offset:8704
    ds_read_b64_tr_b16 v[208:209], v13 offset:16384
    v_mfma_f32_16x16x32_bf16 v[72:75], v[172:175], v[140:143], v[72:75]
    v_mfma_f32_16x16x32_bf16 v[76:79], v[172:175], v[144:147], v[76:79]
    v_mfma_f32_32x32x16_bf16 v[56:71], v[164:167], v[176:179], v[56:71]
    ds_read_b64_tr_b16 v[210:211], v13 offset:16896
    v_add_u32 v9, 0xa000, v9
    v_add_u32 v13, 0xa000, v13
    v_mfma_f32_16x16x32_bf16 v[80:83], v[140:143], v[176:179], v[80:83]
    v_mfma_f32_16x16x32_bf16 v[84:87], v[144:147], v[176:179], v[84:87]
    s_waitcnt vmcnt(5)
    s_waitcnt lgkmcnt(0)
    s_barrier
    v_mfma_f32_32x32x16_bf16 v[24:39], v[184:187], v[180:183], v[24:39]
    ds_read_b128 v[148:151], v6
    ds_read_b64_tr_b16 v[152:153], v10 offset:0
    ds_read_b64_tr_b16 v[154:155], v10 offset:512
    v_mfma_f32_32x32x16_bf16 v[40:55], v[188:191], v[180:183], v[40:55]
    ds_read_b64_tr_b16 v[156:157], v10 offset:8192
    ds_read_b64_tr_b16 v[158:159], v10 offset:8704
    ds_read_b64_tr_b16 v[160:161], v10 offset:16384
    v_mfma_f32_32x32x16_bf16 v[56:71], v[180:183], v[192:195], v[56:71]
    ds_read_b64_tr_b16 v[162:163], v10 offset:16896
    v_add_u32 v6, 0xa000, v6
    v_add_u32 v10, 0xa000, v10
    v_mfma_f32_32x32x16_bf16 v[24:39], v[200:203], v[196:199], v[24:39]
    ds_read_b128 v[164:167], v7
    ds_read_b64_tr_b16 v[168:169], v11 offset:0
    ds_read_b64_tr_b16 v[170:171], v11 offset:512
    v_mfma_f32_16x16x32_bf16 v[88:91], v[100:103], v[200:203], v[88:91]
    v_mfma_f32_32x32x16_bf16 v[40:55], v[204:207], v[196:199], v[40:55]
    ds_read_b64_tr_b16 v[172:173], v11 offset:8192
    ds_read_b64_tr_b16 v[174:175], v11 offset:8704
    ds_read_b64_tr_b16 v[176:177], v11 offset:16384
    v_mfma_f32_16x16x32_bf16 v[92:95], v[100:103], v[204:207], v[92:95]
    v_mfma_f32_32x32x16_bf16 v[56:71], v[196:199], v[208:211], v[56:71]
    ds_read_b64_tr_b16 v[178:179], v11 offset:16896
    ds_read_b128 v[136:139], v14 offset:10240
    v_add_u32 v7, 0xa000, v7
    v_add_u32 v11, 0xa000, v11
    v_mfma_f32_16x16x32_bf16 v[96:99], v[100:103], v[208:211], v[96:99]
    s_waitcnt lgkmcnt(8)
    v_mfma_f32_32x32x16_bf16 v[24:39], v[152:155], v[148:151], v[24:39]
    ds_read_b128 v[180:183], v8
    ds_read_b64_tr_b16 v[184:185], v12 offset:0
    ds_read_b64_tr_b16 v[186:187], v12 offset:512
    v_mfma_f32_32x32x16_bf16 v[40:55], v[156:159], v[148:151], v[40:55]
    ds_read_b64_tr_b16 v[188:189], v12 offset:8192
    ds_read_b64_tr_b16 v[190:191], v12 offset:8704
    ds_read_b64_tr_b16 v[192:193], v12 offset:16384
    v_mfma_f32_32x32x16_bf16 v[56:71], v[148:151], v[160:163], v[56:71]
    ds_read_b64_tr_b16 v[194:195], v12 offset:16896
    v_add_u32 v8, 0xa000, v8
    v_add_u32 v12, 0xa000, v12
    s_waitcnt lgkmcnt(7)
    v_mfma_f32_32x32x16_bf16 v[24:39], v[168:171], v[164:167], v[24:39]
    ds_read_b128 v[196:199], v9
    ds_read_b64_tr_b16 v[200:201], v13 offset:0
    ds_read_b64_tr_b16 v[202:203], v13 offset:512
    v_and_b32 v140, v128, v136
    v_and_b32 v141, v128, v137
    v_and_b32 v142, v128, v138
    v_and_b32 v143, v128, v139
    v_and_b32 v144, v129, v136
    v_and_b32 v145, v129, v137
    v_and_b32 v146, v129, v138
    v_and_b32 v147, v129, v139
    v_mfma_f32_32x32x16_bf16 v[40:55], v[172:175], v[164:167], v[40:55]
    ds_read_b64_tr_b16 v[204:205], v13 offset:8192
    ds_read_b64_tr_b16 v[206:207], v13 offset:8704
    ds_read_b64_tr_b16 v[208:209], v13 offset:16384
    v_mfma_f32_16x16x32_bf16 v[72:75], v[172:175], v[140:143], v[72:75]
    v_mfma_f32_16x16x32_bf16 v[76:79], v[172:175], v[144:147], v[76:79]
    v_mfma_f32_32x32x16_bf16 v[56:71], v[164:167], v[176:179], v[56:71]
    ds_read_b64_tr_b16 v[210:211], v13 offset:16896
    v_add_u32 v9, 0xa000, v9
    v_add_u32 v13, 0xa000, v13
    v_mfma_f32_16x16x32_bf16 v[80:83], v[140:143], v[176:179], v[80:83]
    v_mfma_f32_16x16x32_bf16 v[84:87], v[144:147], v[176:179], v[84:87]
    s_waitcnt vmcnt(0)
    s_waitcnt lgkmcnt(0)
    s_barrier
    s_mov_b32 s48, s16
    s_mov_b32 s49, s17
    s_mov_b32 s50, 1605632
    s_mov_b32 s51, 0x20000
    v_mfma_f32_32x32x16_bf16 v[24:39], v[184:187], v[180:183], v[24:39]
    s_cmp_eq_u32 s75, 0
    s_cbranch_scc0 L_site31
    s_add_u32 m0, s0, s98
    s_nop 0
    buffer_load_dwordx4 v249, s[48:51], s80 offen lds
    s_add_u32 m0, s1, s98
    s_nop 0
    buffer_load_dwordx4 v249, s[48:51], s81 offen lds
    s_add_u32 m0, s3, s98
    s_nop 0
    buffer_load_dwordx4 v249, s[48:51], s82 offen lds
    s_add_u32 m0, s13, s98
    s_nop 0
    buffer_load_dwordx4 v249, s[48:51], s83 offen lds
    s_add_u32 m0, s14, s98
    s_nop 0
    buffer_load_dwordx4 v249, s[48:51], s84 offen lds
    s_add_u32 m0, s15, s98
    s_nop 0
    buffer_load_dwordx4 v249, s[48:51], s85 offen lds
    s_add_u32 m0, s22, s98
    s_nop 0
    buffer_load_dwordx4 v249, s[48:51], s86 offen lds
    s_add_u32 m0, s23, s98
    s_nop 0
    buffer_load_dwordx4 v249, s[48:51], s87 offen lds
L_site31:
    ds_read_b128 v[148:151], v6
    ds_read_b64_tr_b16 v[152:153], v10 offset:0
    ds_read_b64_tr_b16 v[154:155], v10 offset:512
    v_mfma_f32_32x32x16_bf16 v[40:55], v[188:191], v[180:183], v[40:55]
    ds_read_b64_tr_b16 v[156:157], v10 offset:8192
    ds_read_b64_tr_b16 v[158:159], v10 offset:8704
    ds_read_b64_tr_b16 v[160:161], v10 offset:16384
    v_mfma_f32_32x32x16_bf16 v[56:71], v[180:183], v[192:195], v[56:71]
    ds_read_b64_tr_b16 v[162:163], v10 offset:16896
    v_mfma_f32_32x32x16_bf16 v[24:39], v[200:203], v[196:199], v[24:39]
    ds_read_b128 v[164:167], v7
    ds_read_b64_tr_b16 v[168:169], v11 offset:0
    ds_read_b64_tr_b16 v[170:171], v11 offset:512
    v_mfma_f32_16x16x32_bf16 v[88:91], v[100:103], v[200:203], v[88:91]
    v_mfma_f32_32x32x16_bf16 v[40:55], v[204:207], v[196:199], v[40:55]
    ds_read_b64_tr_b16 v[172:173], v11 offset:8192
    ds_read_b64_tr_b16 v[174:175], v11 offset:8704
    ds_read_b64_tr_b16 v[176:177], v11 offset:16384
    v_mfma_f32_16x16x32_bf16 v[92:95], v[100:103], v[204:207], v[92:95]
    v_mfma_f32_32x32x16_bf16 v[56:71], v[196:199], v[208:211], v[56:71]
    ds_read_b64_tr_b16 v[178:179], v11 offset:16896
    ds_read_b128 v[136:139], v14 offset:12288
    v_mfma_f32_16x16x32_bf16 v[96:99], v[100:103], v[208:211], v[96:99]
    s_cmp_eq_u32 s75, 1
    s_cbranch_scc0 L_site32
    s_add_u32 m0, s0, s98
    s_nop 0
    buffer_load_dwordx4 v249, s[48:51], s80 offen lds
    s_add_u32 m0, s1, s98
    s_nop 0
    buffer_load_dwordx4 v249, s[48:51], s81 offen lds
    s_add_u32 m0, s3, s98
    s_nop 0
    buffer_load_dwordx4 v249, s[48:51], s82 offen lds
    s_add_u32 m0, s13, s98
    s_nop 0
    buffer_load_dwordx4 v249, s[48:51], s83 offen lds
    s_add_u32 m0, s14, s98
    s_nop 0
    buffer_load_dwordx4 v249, s[48:51], s84 offen lds
    s_add_u32 m0, s15, s98
    s_nop 0
    buffer_load_dwordx4 v249, s[48:51], s85 offen lds
    s_add_u32 m0, s22, s98
    s_nop 0
    buffer_load_dwordx4 v249, s[48:51], s86 offen lds
    s_add_u32 m0, s23, s98
    s_nop 0
    buffer_load_dwordx4 v249, s[48:51], s87 offen lds
L_site32:
    s_waitcnt lgkmcnt(8)
    s_cmp_eq_u32 s64, 4
    s_cbranch_scc0 L_svc33
    v_cmp_gt_u32 vcc, 1, v253
    s_cbranch_vccz L_so34
    s_mov_b32 s71, 400000
    s_waitcnt vmcnt(0)
L_sl34:
    v_cmp_gt_u32 vcc, 1, v253
    s_cbranch_vccz L_so34
    buffer_load_dword v253, off, s[60:63], 0 sc1
    s_sub_u32 s71, s71, 1
    s_cbranch_scc1 L_sx34
    s_waitcnt vmcnt(0)
    s_branch L_sl34
L_sx34:
    s_waitcnt vmcnt(0)
L_so34:
L_svc33:
    s_lshl_b32 s69, s68, 11
    s_lshl_b32 s70, s67, 7
    s_add_u32 s79, s69, s70
    s_add_u32 s79, s79, 9445376
    s_cmp_eq_u32 s67, 0
    s_cselect_b32 s70, 0, 128
    v_mov_b32 v130, s70
    v_and_b32 v130, v22, v130
    v_sub_u32 v130, s79, v130
    s_cmp_eq_u32 s64, 4
    s_cbranch_scc0 L_svc35
    v_mov_b32 v131, 0
    buffer_load_dword v131, v130, s[36:39], 0 offen sc1
L_svc35:
    v_mfma_f32_32x32x16_bf16 v[24:39], v[152:155], v[148:151], v[24:39]
    ds_read_b128 v[180:183], v8
    ds_read_b64_tr_b16 v[184:185], v12 offset:0
    ds_read_b64_tr_b16 v[186:187], v12 offset:512
    v_mfma_f32_32x32x16_bf16 v[40:55], v[156:159], v[148:151], v[40:55]
    ds_read_b64_tr_b16 v[188:189], v12 offset:8192
    ds_read_b64_tr_b16 v[190:191], v12 offset:8704
    ds_read_b64_tr_b16 v[192:193], v12 offset:16384
    v_mfma_f32_32x32x16_bf16 v[56:71], v[148:151], v[160:163], v[56:71]
    ds_read_b64_tr_b16 v[194:195], v12 offset:16896
    s_waitcnt lgkmcnt(7)
    v_mfma_f32_32x32x16_bf16 v[24:39], v[168:171], v[164:167], v[24:39]
    ds_read_b128 v[196:199], v9
    ds_read_b64_tr_b16 v[200:201], v13 offset:0
    ds_read_b64_tr_b16 v[202:203], v13 offset:512
    v_and_b32 v140, v128, v136
    v_and_b32 v141, v128, v137
    v_and_b32 v142, v128, v138
    v_and_b32 v143, v128, v139
    v_and_b32 v144, v129, v136
    v_and_b32 v145, v129, v137
    v_and_b32 v146, v129, v138
    v_and_b32 v147, v129, v139
    v_mfma_f32_32x32x16_bf16 v[40:55], v[172:175], v[164:167], v[40:55]
    ds_read_b64_tr_b16 v[204:205], v13 offset:8192
    ds_read_b64_tr_b16 v[206:207], v13 offset:8704
    ds_read_b64_tr_b16 v[208:209], v13 offset:16384
    v_mfma_f32_16x16x32_bf16 v[72:75], v[172:175], v[140:143], v[72:75]
    v_mfma_f32_16x16x32_bf16 v[76:79], v[172:175], v[144:147], v[76:79]
    v_mfma_f32_32x32x16_bf16 v[56:71], v[164:167], v[176:179], v[56:71]
    ds_read_b64_tr_b16 v[210:211], v13 offset:16896
    v_mfma_f32_16x16x32_bf16 v[80:83], v[140:143], v[176:179], v[80:83]
    v_mfma_f32_16x16x32_bf16 v[84:87], v[144:147], v[176:179], v[84:87]
    s_waitcnt lgkmcnt(7)
    s_cmp_eq_u32 s64, 4
    s_cbranch_scc0 L_svc36
    v_cmp_gt_u32 vcc, 4, v131
    s_cbranch_vccz L_so37
    s_mov_b32 s71, 400000
    s_waitcnt vmcnt(0)
L_sl37:
    v_cmp_gt_u32 vcc, 4, v131
    s_cbranch_vccz L_so37
    buffer_load_dword v131, v130, s[36:39], 0 offen sc1
    s_sub_u32 s71, s71, 1
    s_cbranch_scc1 L_sx37
    s_waitcnt vmcnt(0)
    s_branch L_sl37
L_sx37:
    s_waitcnt vmcnt(0)
L_so37:
L_svc36:
    s_barrier
    s_lshl_b32 s69, s68, 14
    s_lshl_b32 s70, s67, 9
    s_add_u32 s26, s69, s70
    s_add_u32 s26, s26, 9502720
    s_add_u32 s70, s26, 8192
    v_lshlrev_b32 v130, 2, v240
    s_cmp_eq_u32 s67, 0
    s_cselect_b32 s71, 0x40000000, -64
    v_lshlrev_b32 v131, 2, v241
    v_add_u32 v131, s71, v131
    v_lshlrev_b32 v132, 4, v242
    v_add_u32 v132, s71, v132
    v_add_u32 v131, s26, v131
    v_add_u32 v132, s26, v132
    buffer_load_dword v120, v130, s[36:39], s26 offen sc1
    buffer_load_dword v121, v130, s[36:39], s70 offen sc1
    buffer_load_dword v122, v131, s[36:39], 0 offen sc1
    v_add_u32 v133, 8192, v131
    buffer_load_dword v123, v133, s[36:39], 0 offen sc1
    buffer_load_dwordx4 v[124:127], v132, s[36:39], 0 offen sc1
    buffer_load_dwordx4 v[212:215], v247, s[36:39], s26 offen offset:0 sc1
    buffer_load_dwordx4 v[216:219], v247, s[36:39], s26 offen offset:32 sc1
    buffer_load_dwordx4 v[220:223], v247, s[36:39], s26 offen offset:64 sc1
    buffer_load_dwordx4 v[224:227], v247, s[36:39], s26 offen offset:96 sc1
    v_mfma_f32_32x32x16_bf16 v[24:39], v[184:187], v[180:183], v[24:39]
    v_mfma_f32_32x32x16_bf16 v[40:55], v[188:191], v[180:183], v[40:55]
    v_mfma_f32_32x32x16_bf16 v[56:71], v[180:183], v[192:195], v[56:71]
    s_waitcnt lgkmcnt(0)
    v_mfma_f32_32x32x16_bf16 v[24:39], v[200:203], v[196:199], v[24:39]
    v_mfma_f32_16x16x32_bf16 v[88:91], v[100:103], v[200:203], v[88:91]
    v_mfma_f32_32x32x16_bf16 v[40:55], v[204:207], v[196:199], v[40:55]
    v_mfma_f32_16x16x32_bf16 v[92:95], v[100:103], v[204:207], v[92:95]
    v_mfma_f32_32x32x16_bf16 v[56:71], v[196:199], v[208:211], v[56:71]
    v_mfma_f32_16x16x32_bf16 v[96:99], v[100:103], v[208:211], v[96:99]
    ds_write_b128 v244, v[72:75] offset:0
    ds_write_b128 v244, v[76:79] offset:4096
    ds_write_b128 v244, v[80:83] offset:8192
    ds_write_b128 v244, v[84:87] offset:12288
    ds_write_b32 v239, v88 offset:0
    s_nop 0
    ds_write_b32 v239, v92 offset:512
    s_nop 0
    ds_write_b32 v239, v96 offset:1024
    v_mov_b32 v166, 0
    v_mov_b32 v167, 0
    v_mov_b32 v170, 0
    v_mov_b32 v171, 0
    v_mov_b32 v174, 0
    v_mov_b32 v175, 0
    v_mov_b32 v178, 0
    v_mov_b32 v179, 0
    v_mov_b32 v142, 0
    v_mov_b32 v143, 0
    s_waitcnt vmcnt(0)
    v_and_b32 v121, v22, v121
    v_sub_f32 v121, 0, v121
    v_cvt_pk_bf16_f32 v177, v121, v179
    v_lshlrev_b32 v15, 16, v177
    v_sub_f32 v15, v121, v15
    v_cvt_pk_bf16_f32 v176, v121, v15
    v_and_b32 v123, v251, v123
    v_sub_f32 v123, 0, v123
    v_cvt_pk_bf16_f32 v141, v123, v179
    v_lshlrev_b32 v15, 16, v141
    v_sub_f32 v15, v123, v15
    v_cvt_pk_bf16_f32 v140, v123, v15
    v_mul_f32 v130, 0x3e8b97f6, v120
    v_and_b32 v132, v22, v130
    s_waitcnt lgkmcnt(0)
    s_barrier
    ds_read_b128 v[156:159], v243 offset:1024
    ds_read_b128 v[152:155], v243 offset:512
    ds_read_b128 v[148:151], v243 offset:0
    ds_read_b128 v[72:75], v245 offset:0
    ds_read_b128 v[76:79], v245 offset:1024
    ds_read_b128 v[80:83], v245 offset:2048
    ds_read_b128 v[84:87], v245 offset:3072
    s_waitcnt lgkmcnt(0)
    s_barrier
    v_mov_b32 v15, 163824
    ds_write_b32 v15, v179
    s_add_u32 s89, s98, 65536
    s_add_u32 m0, s0, s89
    s_add_u32 s69, s80, 0xe000
    buffer_load_dwordx4 v249, s[48:51], s69 offen lds
    s_add_u32 m0, s1, s89
    s_add_u32 s69, s81, 0xe000
    buffer_load_dwordx4 v249, s[48:51], s69 offen lds
    v_add_f32 v156, v156, v157
    v_add_f32 v158, v158, v159
    v_add_f32 v156, v156, v158
    v_cvt_pk_bf16_f32 v172, v156, v156
    v_lshlrev_b32 v157, 16, v172
    v_sub_f32 v157, v156, v157
    v_cvt_pk_bf16_f32 v173, v157, v179
    s_add_u32 m0, s3, s89
    s_add_u32 s69, s82, 0xe000
    buffer_load_dwordx4 v249, s[48:51], s69 offen lds
    v_mfma_f32_32x32x16_bf16 v[56:71], v[176:179], v[172:175], v[56:71]
    v_add_f32 v152, v152, v153
    v_add_f32 v154, v154, v155
    v_add_f32 v152, v152, v154
    v_cvt_pk_bf16_f32 v168, v152, v152
    v_lshlrev_b32 v153, 16, v168
    v_sub_f32 v153, v152, v153
    v_cvt_pk_bf16_f32 v169, v153, v179
    s_add_u32 m0, s13, s89
    s_add_u32 s69, s83, 0xe000
    buffer_load_dwordx4 v249, s[48:51], s69 offen lds
    v_mfma_f32_32x32x16_bf16 v[40:55], v[168:171], v[176:179], v[40:55]
    v_add_f32 v148, v148, v149
    v_add_f32 v150, v150, v151
    v_add_f32 v148, v148, v150
    v_cvt_pk_bf16_f32 v164, v148, v148
    v_lshlrev_b32 v149, 16, v164
    v_sub_f32 v149, v148, v149
    v_cvt_pk_bf16_f32 v165, v149, v179
    s_add_u32 m0, s14, s89
    s_add_u32 s69, s84, 0xe000
    buffer_load_dwordx4 v249, s[48:51], s69 offen lds
    v_mfma_f32_32x32x16_bf16 v[24:39], v[164:167], v[176:179], v[24:39]
    v_pk_add_f32 v[72:73], v[72:73], v[76:77]
    v_pk_add_f32 v[74:75], v[74:75], v[78:79]
    v_pk_add_f32 v[80:81], v[80:81], v[84:85]
    v_pk_add_f32 v[82:83], v[82:83], v[86:87]
    v_pk_add_f32 v[72:73], v[72:73], v[80:81]
    v_pk_add_f32 v[74:75], v[74:75], v[82:83]
    s_add_u32 m0, s15, s89
    s_add_u32 s69, s85, 0xe000
    buffer_load_dwordx4 v249, s[48:51], s69 offen lds
    s_add_u32 m0, s22, s89
    s_add_u32 s69, s86, 0xe000
    buffer_load_dwordx4 v249, s[48:51], s69 offen lds
    s_add_u32 m0, s23, s89
    s_add_u32 s69, s87, 0xe000
    buffer_load_dwordx4 v249, s[48:51], s69 offen lds
    s_cmp_lt_u32 s74, 2
    s_cbranch_scc0 L_hv
    v_mfma_f32_16x16x32_bf16 v[72:75], v[168:171], v[140:143], v[72:75]
    s_branch L_hd
L_hv:
    v_mfma_f32_16x16x32_bf16 v[72:75], v[140:143], v[172:175], v[72:75]
L_hd:
    v_pk_mul_f32 v[56:57], v[56:57], v[212:213]
    v_pk_mul_f32 v[58:59], v[58:59], v[214:215]
    v_pk_mul_f32 v[60:61], v[60:61], v[216:217]
    v_pk_mul_f32 v[62:63], v[62:63], v[218:219]
    v_pk_mul_f32 v[64:65], v[64:65], v[220:221]
    v_pk_mul_f32 v[66:67], v[66:67], v[222:223]
    v_pk_mul_f32 v[68:69], v[68:69], v[224:225]
    v_pk_mul_f32 v[70:71], v[70:71], v[226:227]
    v_cvt_pk_bf16_f32 v226, v56, v57
    v_cvt_pk_bf16_f32 v227, v58, v59
    v_cvt_pk_bf16_f32 v232, v60, v61
    v_cvt_pk_bf16_f32 v233, v62, v63
    v_cvt_pk_bf16_f32 v228, v64, v65
    v_cvt_pk_bf16_f32 v229, v66, v67
    v_cvt_pk_bf16_f32 v234, v68, v69
    v_cvt_pk_bf16_f32 v235, v70, v71
    v_permlane32_swap_b32 v226, v232
    v_permlane32_swap_b32 v227, v233
    v_permlane32_swap_b32 v228, v234
    v_permlane32_swap_b32 v229, v235
    v_permlane16_swap_b32 v226, v232
    v_permlane16_swap_b32 v227, v233
    v_permlane16_swap_b32 v228, v234
    v_permlane16_swap_b32 v229, v235
    ds_write_b64 v135, v[228:229] offset:1024
    ds_write_b64 v135, v[234:235] offset:1032
    v_pk_mul_f32 v[40:41], v[40:41], v[120:121] op_sel_hi:[1,0]
    v_pk_mul_f32 v[42:43], v[42:43], v[120:121] op_sel_hi:[1,0]
    v_pk_mul_f32 v[44:45], v[44:45], v[120:121] op_sel_hi:[1,0]
    v_pk_mul_f32 v[46:47], v[46:47], v[120:121] op_sel_hi:[1,0]
    v_pk_mul_f32 v[48:49], v[48:49], v[120:121] op_sel_hi:[1,0]
    v_pk_mul_f32 v[50:51], v[50:51], v[120:121] op_sel_hi:[1,0]
    v_pk_mul_f32 v[52:53], v[52:53], v[120:121] op_sel_hi:[1,0]
    v_pk_mul_f32 v[54:55], v[54:55], v[120:121] op_sel_hi:[1,0]
    v_cvt_pk_bf16_f32 v216, v40, v41
    v_cvt_pk_bf16_f32 v217, v42, v43
    v_cvt_pk_bf16_f32 v220, v44, v45
    v_cvt_pk_bf16_f32 v221, v46, v47
    v_cvt_pk_bf16_f32 v218, v48, v49
    v_cvt_pk_bf16_f32 v219, v50, v51
    v_cvt_pk_bf16_f32 v222, v52, v53
    v_cvt_pk_bf16_f32 v223, v54, v55
    v_permlane32_swap_b32 v216, v220
    v_permlane32_swap_b32 v217, v221
    v_permlane32_swap_b32 v218, v222
    v_permlane32_swap_b32 v219, v223
    v_permlane16_swap_b32 v216, v220
    v_permlane16_swap_b32 v217, v221
    v_permlane16_swap_b32 v218, v222
    v_permlane16_swap_b32 v219, v223
    ds_write_b128 v135, v[220:223]
    s_cmp_lt_u32 s74, 2
    s_cbranch_scc0 L_hv2
    v_pk_mul_f32 v[72:73], v[72:73], v[122:123] op_sel_hi:[1,0]
    v_pk_mul_f32 v[74:75], v[74:75], v[122:123] op_sel_hi:[1,0]
    s_branch L_hd2
L_hv2:
    v_pk_mul_f32 v[72:73], v[72:73], v[124:125]
    v_pk_mul_f32 v[74:75], v[74:75], v[126:127]
L_hd2:
    v_cvt_pk_bf16_f32 v76, v72, v73
    v_cvt_pk_bf16_f32 v77, v74, v75
    ds_write_b64 v20, v[76:77]
    s_waitcnt lgkmcnt(0)
    s_barrier
    ds_read_b128 v[212:215], v19
    ds_read_b64 v[224:225], v19 offset:1024
    ds_read_b64 v[230:231], v19 offset:1032
    s_cmp_eq_u32 s64, 4
    s_cbranch_scc0 L_svc38
    v_mov_b32 v252, 0
    buffer_load_dword v252, off, s[36:39], s92 sc1
L_svc38:
    v_pk_mul_f32 v[24:25], v[24:25], v[130:131] op_sel_hi:[1,0]
    v_pk_mul_f32 v[26:27], v[26:27], v[130:131] op_sel_hi:[1,0]
    v_pk_mul_f32 v[28:29], v[28:29], v[130:131] op_sel_hi:[1,0]
    v_pk_mul_f32 v[30:31], v[30:31], v[130:131] op_sel_hi:[1,0]
    v_pk_mul_f32 v[32:33], v[32:33], v[130:131] op_sel_hi:[1,0]
    v_pk_mul_f32 v[34:35], v[34:35], v[130:131] op_sel_hi:[1,0]
    v_pk_mul_f32 v[36:37], v[36:37], v[132:133] op_sel_hi:[1,0]
    v_pk_mul_f32 v[38:39], v[38:39], v[132:133] op_sel_hi:[1,0]
    v_cvt_pk_bf16_f32 v204, v24, v25
    v_cvt_pk_bf16_f32 v205, v26, v27
    v_cvt_pk_bf16_f32 v208, v28, v29
    v_cvt_pk_bf16_f32 v209, v30, v31
    v_cvt_pk_bf16_f32 v206, v32, v33
    v_cvt_pk_bf16_f32 v207, v34, v35
    v_cvt_pk_bf16_f32 v210, v36, v37
    v_cvt_pk_bf16_f32 v211, v38, v39
    v_permlane32_swap_b32 v204, v208
    v_permlane32_swap_b32 v205, v209
    v_permlane32_swap_b32 v206, v210
    v_permlane32_swap_b32 v207, v211
    v_permlane16_swap_b32 v204, v208
    v_permlane16_swap_b32 v205, v209
    v_permlane16_swap_b32 v206, v210
    v_permlane16_swap_b32 v207, v211
    s_waitcnt lgkmcnt(0)
    s_nop 0
    v_mfma_f32_16x16x32_bf16 v[48:51], v[216:219], v[208:211], v[108:111]
    v_mfma_f32_16x16x32_bf16 v[52:55], v[220:223], v[208:211], v[112:115]
    v_mfma_f32_16x16x32_bf16 v[44:47], v[216:219], v[204:207], v[112:115]
    v_mfma_f32_16x16x32_bf16 v[40:43], v[212:215], v[204:207], v[116:119]
    s_nop 4
    v_max3_f32 v18, v48, v49, v50
    v_max3_f32 v19, v51, v52, v53
    v_max3_f32 v18, v18, v54, v55
    v_max_f32 v18, v18, v19
    v_mov_b32 v19, v18
    v_max3_f32 v16, v40, v41, v42
    v_max3_f32 v17, v43, v44, v45
    v_max3_f32 v16, v16, v46, v47
    v_max_f32 v16, v16, v17
    v_mov_b32 v17, v16
    v_permlane16_swap_b32 v18, v19
    s_nop 0
    v_permlane16_swap_b32 v16, v17
    v_max_f32 v18, v18, v19
    v_mov_b32 v19, v18
    v_max_f32 v16, v16, v17
    v_mov_b32 v17, v16
    v_permlane32_swap_b32 v18, v19
    s_nop 0
    v_permlane32_swap_b32 v16, v17
    v_max_f32 v18, v18, v19
    v_max_f32 v16, v16, v17
    v_pk_add_f32 v[48:49], v[48:49], v[18:19] op_sel_hi:[1,0] neg_lo:[0,1] neg_hi:[0,1]
    v_pk_add_f32 v[50:51], v[50:51], v[18:19] op_sel_hi:[1,0] neg_lo:[0,1] neg_hi:[0,1]
    v_pk_add_f32 v[52:53], v[52:53], v[18:19] op_sel_hi:[1,0] neg_lo:[0,1] neg_hi:[0,1]
    v_pk_add_f32 v[54:55], v[54:55], v[18:19] op_sel_hi:[1,0] neg_lo:[0,1] neg_hi:[0,1]
    v_exp_f32 v48, v48
    v_exp_f32 v49, v49
    v_exp_f32 v50, v50
    v_exp_f32 v51, v51
    v_exp_f32 v52, v52
    v_exp_f32 v53, v53
    v_exp_f32 v54, v54
    v_exp_f32 v55, v55
    v_cvt_pk_bf16_f32 v60, v48, v49
    v_cvt_pk_bf16_f32 v61, v50, v51
    v_cvt_pk_bf16_f32 v62, v52, v53
    v_cvt_pk_bf16_f32 v63, v54, v55
    s_nop 1
    v_mfma_f32_16x16x32_bf16 v[96:99], v[104:107], v[60:63], 0
    v_mfma_f32_16x16x32_bf16 v[88:91], v[226:229], v[60:63], 0
    v_mfma_f32_16x16x32_bf16 v[92:95], v[232:235], v[60:63], 0
    v_pk_add_f32 v[40:41], v[40:41], v[16:17] op_sel_hi:[1,0] neg_lo:[0,1] neg_hi:[0,1]
    v_pk_add_f32 v[42:43], v[42:43], v[16:17] op_sel_hi:[1,0] neg_lo:[0,1] neg_hi:[0,1]
    v_pk_add_f32 v[44:45], v[44:45], v[16:17] op_sel_hi:[1,0] neg_lo:[0,1] neg_hi:[0,1]
    v_pk_add_f32 v[46:47], v[46:47], v[16:17] op_sel_hi:[1,0] neg_lo:[0,1] neg_hi:[0,1]
    v_exp_f32 v40, v40
    v_exp_f32 v41, v41
    v_exp_f32 v42, v42
    v_exp_f32 v43, v43
    v_exp_f32 v44, v44
    v_exp_f32 v45, v45
    v_exp_f32 v46, v46
    v_exp_f32 v47, v47
    v_cvt_pk_bf16_f32 v56, v40, v41
    v_cvt_pk_bf16_f32 v57, v42, v43
    v_cvt_pk_bf16_f32 v58, v44, v45
    v_cvt_pk_bf16_f32 v59, v46, v47
    s_nop 1
    v_mfma_f32_16x16x32_bf16 v[32:35], v[104:107], v[56:59], 0
    v_mfma_f32_16x16x32_bf16 v[24:27], v[224:227], v[56:59], 0
    v_mfma_f32_16x16x32_bf16 v[28:31], v[230:233], v[56:59], 0
    v_rcp_f32 v96, v96
    s_nop 0
    v_and_b32 v98, v5, v96
    v_pk_mul_f32 v[88:89], v[88:89], v[96:97] op_sel_hi:[1,0]
    v_pk_mul_f32 v[90:91], v[90:91], v[96:97] op_sel_hi:[1,0]
    v_pk_mul_f32 v[92:93], v[92:93], v[98:99] op_sel_hi:[1,0]
    v_pk_mul_f32 v[94:95], v[94:95], v[98:99] op_sel_hi:[1,0]
    v_cvt_pk_bf16_f32 v60, v88, v89
    v_cvt_pk_bf16_f32 v61, v90, v91
    v_cvt_pk_bf16_f32 v62, v92, v93
    v_cvt_pk_bf16_f32 v63, v94, v95
    buffer_store_dwordx4 v[60:63], v21, s[36:39], s76 offen offset:256 sc1
    v_rcp_f32 v32, v32
    s_nop 0
    v_and_b32 v34, v5, v32
    v_pk_mul_f32 v[24:25], v[24:25], v[32:33] op_sel_hi:[1,0]
    v_pk_mul_f32 v[26:27], v[26:27], v[32:33] op_sel_hi:[1,0]
    v_pk_mul_f32 v[28:29], v[28:29], v[34:35] op_sel_hi:[1,0]
    v_pk_mul_f32 v[30:31], v[30:31], v[34:35] op_sel_hi:[1,0]
    v_cvt_pk_bf16_f32 v56, v24, v25
    v_cvt_pk_bf16_f32 v57, v26, v27
    v_cvt_pk_bf16_f32 v58, v28, v29
    v_cvt_pk_bf16_f32 v59, v30, v31
    buffer_store_dwordx4 v[56:59], v21, s[36:39], s76 offen offset:0 sc1
    s_branch L_s1_done
L_s1_done:
    s_cmp_ge_u32 s66, 28
    s_cbranch_scc1 L_nos2
    s_lshr_b32 s76, s64, 1
    s_and_b32 s77, s64, 1
    s_lshl_b32 s70, s77, 10
    s_mul_i32 s74, s76, 100352
    s_mov_b32 s44, s8
    s_mov_b32 s45, s9
    s_mov_b32 s46, 401408
    s_mov_b32 s47, 0x20000
    s_lshl_b32 s69, s76, 13
    s_add_u32 s75, s69, s70
    v_lshlrev_b32 v3, 4, v1
    s_lshl_b32 s69, s90, 1
    s_add_u32 s69, s69, s77
    s_mul_i32 s78, s69, 114688
    s_mul_i32 s70, s76, 28672
    s_add_u32 s78, s78, s70
    s_lshl_b32 s79, s69, 15
    s_lshl_b32 s70, s76, 13
    s_add_u32 s79, s79, s70
    s_add_u32 s79, s79, 7340032
    s_lshl_b32 s94, s69, 5
    s_cmp_eq_u32 s64, 4
    s_cbranch_scc0 L_svc39
    v_cmp_gt_u32 vcc, 8, v252
    s_cbranch_vccz L_so40
    s_mov_b32 s71, 400000
    s_waitcnt vmcnt(0)
L_sl40:
    v_cmp_gt_u32 vcc, 8, v252
    s_cbranch_vccz L_so40
    buffer_load_dword v252, off, s[36:39], s92 sc1
    s_sub_u32 s71, s71, 1
    s_cbranch_scc1 L_sx40
    s_waitcnt vmcnt(0)
    s_branch L_sl40
L_sx40:
    s_waitcnt vmcnt(0)
L_so40:
L_svc39:
    s_barrier
    s_add_u32 s89, s98, 65536
    buffer_load_dwordx4 v[116:119], v3, s[36:39], s78 offen offset:0 sc1
    buffer_load_dwordx4 v[120:123], v3, s[36:39], s78 offen offset:1024 sc1
    buffer_load_dwordx4 v[124:127], v3, s[36:39], s78 offen offset:2048 sc1
    buffer_load_dwordx4 v[128:131], v3, s[36:39], s78 offen offset:3072 sc1
    s_add_u32 s70, s78, 16384
    buffer_load_dwordx4 v[132:135], v3, s[36:39], s70 offen offset:0 sc1
    s_add_u32 s70, s78, 16384
    buffer_load_dwordx4 v[136:139], v3, s[36:39], s70 offen offset:1024 sc1
    s_add_u32 s95, s92, 4096
    s_cmp_eq_u32 s64, 4
    s_cbranch_scc0 L_svc41
    v_mov_b32 v251, 0
    buffer_load_dword v251, off, s[36:39], s95 sc1
L_svc41:
    s_mov_b32 s52, s20
    s_mov_b32 s53, s21
    s_mov_b32 s54, 1835008
    s_mov_b32 s55, 0x20000
    s_mov_b32 s56, s18
    s_mov_b32 s57, s19
    s_mov_b32 s58, 896
    s_mov_b32 s59, 0x20000
    v_lshrrev_b32 v15, 5, v1
    v_lshlrev_b32 v15, 2, v15
    v_bfe_u32 v16, v1, 2, 2
    v_add_u32 v15, v15, v16
    v_lshlrev_b32 v15, 7, v15
    v_and_b32 v16, 16, v1
    v_lshlrev_b32 v16, 1, v16
    v_and_b32 v17, 3, v1
    v_lshl_add_u32 v16, v17, 3, v16
    v_and_b32 v17, 8, v1
    v_lshlrev_b32 v17, 3, v17
    v_xor_b32 v16, v16, v17
    v_add_u32 v15, v15, v16
    s_lshl_b32 s69, s76, 5
    v_xor_b32 v15, s69, v15
    s_lshl_b32 s69, s76, 14
    v_add_u32 v4, s69, v15
    v_xor_b32 v5, 64, v4
    v_add_u32 v6, 65536, v4
    v_add_u32 v7, 65536, v5
    s_lshl_b32 s70, s76, 13
    s_add_u32 s70, s70, 131072
    v_add_u32 v8, s70, v15
    v_xor_b32 v9, 64, v8
    v_and_b32 v16, 31, v1
    v_add_u32 v16, s94, v16
    v_mul_u32_u24 v16, 896, v16
    v_lshrrev_b32 v17, 5, v1
    v_lshlrev_b32 v17, 4, v17
    s_lshl_b32 s70, s91, 7
    s_lshl_b32 s71, s76, 5
    s_add_u32 s70, s70, s71
    v_add_u32 v17, s70, v17
    v_add_u32 v10, v16, v17
    s_mul_i32 s70, s77, 6144
    v_add_u32 v15, s70, v3
    v_add_u32 v14, s69, v15
    s_xor_b32 s71, s76, 1
    s_lshl_b32 s71, s71, 14
    s_add_u32 s71, s71, 0
    v_add_u32 v11, s71, v15
    s_xor_b32 s71, s76, 2
    s_lshl_b32 s71, s71, 14
    s_add_u32 s71, s71, 2048
    v_add_u32 v12, s71, v15
    s_xor_b32 s71, s76, 3
    s_lshl_b32 s71, s71, 14
    s_add_u32 s71, s71, 4096
    v_add_u32 v13, s71, v15
    s_cmp_eq_u32 s64, 4
    s_cbranch_scc0 L_svc42
    v_cmp_gt_u32 vcc, 8, v251
    s_cbranch_vccz L_so43
    s_mov_b32 s71, 400000
    s_waitcnt vmcnt(0)
L_sl43:
    v_cmp_gt_u32 vcc, 8, v251
    s_cbranch_vccz L_so43
    buffer_load_dword v251, off, s[36:39], s95 sc1
    s_sub_u32 s71, s71, 1
    s_cbranch_scc1 L_sx43
    s_waitcnt vmcnt(0)
    s_branch L_sl43
L_sx43:
    s_waitcnt vmcnt(0)
L_so43:
L_svc42:
    s_waitcnt vmcnt(6)
    s_barrier
    s_cmp_eq_u32 s64, 4
    s_cbranch_scc0 L_svc44
    s_lshl_b32 s69, s67, 7
    s_add_u32 s69, s69, 9439232
    s_lshr_b32 s70, s66, 4
    s_lshl_b32 s70, s70, 31
    s_lshl_b32 s70, s70, 1
    s_add_u32 s69, s69, s70
    v_mov_b32 v253, 1
    s_mov_b64 exec, 1
    buffer_atomic_add v253, off, s[36:39], s69 sc1
    s_mov_b64 exec, -1
L_svc44:
    ds_read_b64_tr_b16 v[28:29], v4 offset:0
    ds_read_b64_tr_b16 v[30:31], v4 offset:1024
    ds_read_b64_tr_b16 v[32:33], v5 offset:0
    ds_read_b64_tr_b16 v[34:35], v5 offset:1024
    ds_read_b64_tr_b16 v[36:37], v4 offset:2048
    ds_read_b64_tr_b16 v[38:39], v4 offset:3072
    ds_read_b64_tr_b16 v[40:41], v5 offset:2048
    ds_read_b64_tr_b16 v[42:43], v5 offset:3072
    ds_read_b64_tr_b16 v[44:45], v4 offset:4096
    ds_read_b64_tr_b16 v[46:47], v4 offset:5120
    ds_read_b64_tr_b16 v[48:49], v5 offset:4096
    ds_read_b64_tr_b16 v[50:51], v5 offset:5120
    s_waitcnt lgkmcnt(8)
    s_waitcnt vmcnt(5)
    v_mfma_f32_32x32x16_bf16 v[52:67], v[28:31], v[116:119], 0
    s_add_u32 s70, s78, 16384
    buffer_load_dwordx4 v[140:143], v3, s[36:39], s70 offen offset:2048 sc1
    s_add_u32 s70, s78, 16384
    buffer_load_dwordx4 v[144:147], v3, s[36:39], s70 offen offset:3072 sc1
    v_mfma_f32_32x32x16_bf16 v[68:83], v[32:35], v[116:119], 0
    s_add_u32 s70, s78, 4096
    buffer_load_dwordx4 v[148:151], v3, s[36:39], s70 offen offset:0 sc1
    ds_read_b64_tr_b16 v[28:29], v4 offset:6144
    ds_read_b64_tr_b16 v[30:31], v4 offset:7168
    ds_read_b64_tr_b16 v[32:33], v5 offset:6144
    ds_read_b64_tr_b16 v[34:35], v5 offset:7168
    s_waitcnt lgkmcnt(8)
    s_waitcnt vmcnt(7)
    v_mfma_f32_32x32x16_bf16 v[52:67], v[36:39], v[120:123], v[52:67]
    s_add_u32 s70, s78, 4096
    buffer_load_dwordx4 v[152:155], v3, s[36:39], s70 offen offset:1024 sc1
    s_add_u32 s70, s78, 4096
    buffer_load_dwordx4 v[156:159], v3, s[36:39], s70 offen offset:2048 sc1
    v_mfma_f32_32x32x16_bf16 v[68:83], v[40:43], v[120:123], v[68:83]
    s_add_u32 s70, s78, 4096
    buffer_load_dwordx4 v[160:163], v3, s[36:39], s70 offen offset:3072 sc1
    ds_read_b64_tr_b16 v[36:37], v4 offset:8192
    ds_read_b64_tr_b16 v[38:39], v4 offset:9216
    ds_read_b64_tr_b16 v[40:41], v5 offset:8192
    ds_read_b64_tr_b16 v[42:43], v5 offset:9216
    s_waitcnt lgkmcnt(8)
    s_waitcnt vmcnt(9)
    v_mfma_f32_32x32x16_bf16 v[52:67], v[44:47], v[124:127], v[52:67]
    s_add_u32 s70, s78, 20480
    buffer_load_dwordx4 v[164:167], v3, s[36:39], s70 offen offset:0 sc1
    s_add_u32 s70, s78, 20480
    buffer_load_dwordx4 v[168:171], v3, s[36:39], s70 offen offset:1024 sc1
    v_mfma_f32_32x32x16_bf16 v[68:83], v[48:51], v[124:127], v[68:83]
    s_add_u32 s70, s78, 20480
    buffer_load_dwordx4 v[172:175], v3, s[36:39], s70 offen offset:2048 sc1
    ds_read_b64_tr_b16 v[44:45], v4 offset:10240
    ds_read_b64_tr_b16 v[46:47], v4 offset:11264
    ds_read_b64_tr_b16 v[48:49], v5 offset:10240
    ds_read_b64_tr_b16 v[50:51], v5 offset:11264
    s_waitcnt lgkmcnt(8)
    s_waitcnt vmcnt(11)
    v_mfma_f32_32x32x16_bf16 v[52:67], v[28:31], v[128:131], v[52:67]
    s_add_u32 s70, s78, 20480
    buffer_load_dwordx4 v[176:179], v3, s[36:39], s70 offen offset:3072 sc1
    s_add_u32 m0, s75, 131072
    s_add_u32 s69, s99, 172032
    buffer_load_dwordx4 v249, s[48:51], s69 offen lds
    v_mfma_f32_32x32x16_bf16 v[68:83], v[32:35], v[128:131], v[68:83]
    s_add_u32 m0, s75, 133120
    s_add_u32 s69, s99, 186368
    buffer_load_dwordx4 v249, s[48:51], s69 offen lds
    ds_read_b64_tr_b16 v[28:29], v4 offset:12288
    ds_read_b64_tr_b16 v[30:31], v4 offset:13312
    ds_read_b64_tr_b16 v[32:33], v5 offset:12288
    ds_read_b64_tr_b16 v[34:35], v5 offset:13312
    s_waitcnt lgkmcnt(8)
    s_waitcnt vmcnt(13)
    v_mfma_f32_32x32x16_bf16 v[52:67], v[36:39], v[132:135], v[52:67]
    s_add_u32 m0, s75, 135168
    s_add_u32 s69, s99, 200704
    buffer_load_dwordx4 v249, s[48:51], s69 offen lds
    v_mfma_f32_32x32x16_bf16 v[68:83], v[40:43], v[132:135], v[68:83]
    s_add_u32 m0, s75, 137216
    s_add_u32 s69, s99, 215040
    buffer_load_dwordx4 v249, s[48:51], s69 offen lds
    ds_read_b64_tr_b16 v[36:37], v4 offset:14336
    ds_read_b64_tr_b16 v[38:39], v4 offset:15360
    ds_read_b64_tr_b16 v[40:41], v5 offset:14336
    ds_read_b64_tr_b16 v[42:43], v5 offset:15360
    s_waitcnt lgkmcnt(8)
    s_waitcnt vmcnt(14)
    v_mfma_f32_32x32x16_bf16 v[52:67], v[44:47], v[136:139], v[52:67]
    v_mfma_f32_32x32x16_bf16 v[68:83], v[48:51], v[136:139], v[68:83]
    s_waitcnt lgkmcnt(0)
    s_barrier
    s_add_u32 s95, s92, 2048
    s_cmp_eq_u32 s64, 4
    s_cbranch_scc0 L_svc45
    v_mov_b32 v251, 0
    buffer_load_dword v251, off, s[36:39], s95 sc1
L_svc45:
    ds_read_b64_tr_b16 v[44:45], v6 offset:0
    ds_read_b64_tr_b16 v[46:47], v6 offset:1024
    ds_read_b64_tr_b16 v[48:49], v7 offset:0
    ds_read_b64_tr_b16 v[50:51], v7 offset:1024
    s_waitcnt vmcnt(13)
    v_mfma_f32_32x32x16_bf16 v[52:67], v[28:31], v[140:143], v[52:67]
    s_add_u32 m0, s0, s98
    s_add_u32 s69, s80, 0x1c000
    buffer_load_dwordx4 v249, s[48:51], s69 offen lds
    s_add_u32 m0, s1, s98
    s_add_u32 s69, s81, 0x1c000
    buffer_load_dwordx4 v249, s[48:51], s69 offen lds
    v_mfma_f32_32x32x16_bf16 v[68:83], v[32:35], v[140:143], v[68:83]
    s_add_u32 m0, s3, s98
    s_add_u32 s69, s82, 0x1c000
    buffer_load_dwordx4 v249, s[48:51], s69 offen lds
    ds_read_b64_tr_b16 v[28:29], v6 offset:2048
    ds_read_b64_tr_b16 v[30:31], v6 offset:3072
    ds_read_b64_tr_b16 v[32:33], v7 offset:2048
    ds_read_b64_tr_b16 v[34:35], v7 offset:3072
    s_waitcnt vmcnt(15)
    v_mfma_f32_32x32x16_bf16 v[52:67], v[36:39], v[144:147], v[52:67]
    s_add_u32 m0, s13, s98
    s_add_u32 s69, s83, 0x1c000
    buffer_load_dwordx4 v249, s[48:51], s69 offen lds
    s_add_u32 m0, s14, s98
    s_add_u32 s69, s84, 0x1c000
    buffer_load_dwordx4 v249, s[48:51], s69 offen lds
    v_mfma_f32_32x32x16_bf16 v[68:83], v[40:43], v[144:147], v[68:83]
    s_add_u32 m0, s15, s98
    s_add_u32 s69, s85, 0x1c000
    buffer_load_dwordx4 v249, s[48:51], s69 offen lds
    ds_read_b64_tr_b16 v[36:37], v6 offset:4096
    ds_read_b64_tr_b16 v[38:39], v6 offset:5120
    ds_read_b64_tr_b16 v[40:41], v7 offset:4096
    ds_read_b64_tr_b16 v[42:43], v7 offset:5120
    s_waitcnt lgkmcnt(8)
    s_waitcnt vmcnt(17)
    v_mfma_f32_32x32x16_bf16 v[52:67], v[44:47], v[148:151], v[52:67]
    s_add_u32 m0, s22, s98
    s_add_u32 s69, s86, 0x1c000
    buffer_load_dwordx4 v249, s[48:51], s69 offen lds
    v_mfma_f32_32x32x16_bf16 v[68:83], v[48:51], v[148:151], v[68:83]
    s_add_u32 m0, s23, s98
    s_add_u32 s69, s87, 0x1c000
    buffer_load_dwordx4 v249, s[48:51], s69 offen lds
    s_cmp_eq_u32 s64, 4
    s_cbranch_scc0 L_svc46
    v_cmp_gt_u32 vcc, 16, v251
    s_cbranch_vccz L_so47
    s_mov_b32 s71, 400000
    s_waitcnt vmcnt(0)
L_sl47:
    v_cmp_gt_u32 vcc, 16, v251
    s_cbranch_vccz L_so47
    buffer_load_dword v251, off, s[36:39], s95 sc1
    s_sub_u32 s71, s71, 1
    s_cbranch_scc1 L_sx47
    s_waitcnt vmcnt(0)
    s_branch L_sl47
L_sx47:
    s_waitcnt vmcnt(0)
L_so47:
L_svc46:
    s_barrier
    buffer_load_dwordx4 v[24:27], v17, s[56:59], 0 offen
    ds_read_b64_tr_b16 v[44:45], v6 offset:6144
    ds_read_b64_tr_b16 v[46:47], v6 offset:7168
    ds_read_b64_tr_b16 v[48:49], v7 offset:6144
    ds_read_b64_tr_b16 v[50:51], v7 offset:7168
    s_waitcnt lgkmcnt(8)
    s_waitcnt vmcnt(19)
    v_mfma_f32_32x32x16_bf16 v[52:67], v[28:31], v[152:155], v[52:67]
    s_add_u32 s70, s78, 8192
    buffer_load_dwordx4 v[180:183], v3, s[36:39], s70 offen offset:0 sc1
    s_add_u32 s70, s78, 8192
    buffer_load_dwordx4 v[184:187], v3, s[36:39], s70 offen offset:1024 sc1
    v_mfma_f32_32x32x16_bf16 v[68:83], v[32:35], v[152:155], v[68:83]
    s_add_u32 s70, s78, 8192
    buffer_load_dwordx4 v[188:191], v3, s[36:39], s70 offen offset:2048 sc1
    s_add_u32 s70, s78, 8192
    buffer_load_dwordx4 v[192:195], v3, s[36:39], s70 offen offset:3072 sc1
    ds_read_b64_tr_b16 v[28:29], v6 offset:8192
    ds_read_b64_tr_b16 v[30:31], v6 offset:9216
    ds_read_b64_tr_b16 v[32:33], v7 offset:8192
    ds_read_b64_tr_b16 v[34:35], v7 offset:9216
    s_waitcnt lgkmcnt(8)
    s_waitcnt vmcnt(22)
    v_mfma_f32_32x32x16_bf16 v[52:67], v[36:39], v[156:159], v[52:67]
    s_add_u32 s70, s78, 24576
    buffer_load_dwordx4 v[196:199], v3, s[36:39], s70 offen offset:0 sc1
    s_add_u32 s70, s78, 24576
    buffer_load_dwordx4 v[200:203], v3, s[36:39], s70 offen offset:1024 sc1
    v_mfma_f32_32x32x16_bf16 v[68:83], v[40:43], v[156:159], v[68:83]
    s_add_u32 s70, s78, 24576
    buffer_load_dwordx4 v[204:207], v3, s[36:39], s70 offen offset:2048 sc1
    s_add_u32 s70, s78, 24576
    buffer_load_dwordx4 v[208:211], v3, s[36:39], s70 offen offset:3072 sc1
    ds_read_b64_tr_b16 v[36:37], v6 offset:10240
    ds_read_b64_tr_b16 v[38:39], v6 offset:11264
    ds_read_b64_tr_b16 v[40:41], v7 offset:10240
    ds_read_b64_tr_b16 v[42:43], v7 offset:11264
    s_waitcnt lgkmcnt(8)
    s_waitcnt vmcnt(25)
    v_mfma_f32_32x32x16_bf16 v[52:67], v[44:47], v[160:163], v[52:67]
    s_add_u32 s70, s78, 12288
    buffer_load_dwordx4 v[212:215], v3, s[36:39], s70 offen offset:0 sc1
    s_add_u32 s70, s78, 12288
    buffer_load_dwordx4 v[216:219], v3, s[36:39], s70 offen offset:1024 sc1
    v_mfma_f32_32x32x16_bf16 v[68:83], v[48:51], v[160:163], v[68:83]
    s_add_u32 s70, s78, 12288
    buffer_load_dwordx4 v[220:223], v3, s[36:39], s70 offen offset:2048 sc1
    s_add_u32 s70, s78, 12288
    buffer_load_dwordx4 v[224:227], v3, s[36:39], s70 offen offset:3072 sc1
    ds_read_b64_tr_b16 v[44:45], v6 offset:12288
    ds_read_b64_tr_b16 v[46:47], v6 offset:13312
    ds_read_b64_tr_b16 v[48:49], v7 offset:12288
    ds_read_b64_tr_b16 v[50:51], v7 offset:13312
    s_waitcnt lgkmcnt(8)
    s_waitcnt vmcnt(28)
    v_mfma_f32_32x32x16_bf16 v[52:67], v[28:31], v[164:167], v[52:67]
    v_mfma_f32_32x32x16_bf16 v[68:83], v[32:35], v[164:167], v[68:83]
    ds_read_b64_tr_b16 v[28:29], v6 offset:14336
    ds_read_b64_tr_b16 v[30:31], v6 offset:15360
    ds_read_b64_tr_b16 v[32:33], v7 offset:14336
    ds_read_b64_tr_b16 v[34:35], v7 offset:15360
    s_waitcnt lgkmcnt(8)
    s_waitcnt vmcnt(27)
    v_mfma_f32_32x32x16_bf16 v[52:67], v[36:39], v[168:171], v[52:67]
    v_mfma_f32_32x32x16_bf16 v[68:83], v[40:43], v[168:171], v[68:83]
    s_waitcnt lgkmcnt(0)
    s_waitcnt vmcnt(13)
    s_barrier
    ds_read_b64_tr_b16 v[36:37], v4 offset:0
    ds_read_b64_tr_b16 v[38:39], v4 offset:1024
    ds_read_b64_tr_b16 v[40:41], v5 offset:0
    ds_read_b64_tr_b16 v[42:43], v5 offset:1024
    v_mfma_f32_32x32x16_bf16 v[52:67], v[44:47], v[172:175], v[52:67]
    s_cmp_eq_u32 s0, 0x3800
    s_cbranch_scc1 L_xd48
    s_add_u32 m0, s0, s89
    s_mul_i32 s69, s0, 7
    s_add_u32 s69, s69, s74
    buffer_load_dwordx4 v249, s[44:47], s69 offen lds
    s_branch L_xe48
L_xd48:
    s_add_u32 m0, s89, 0x3800
    s_lshl_b32 s69, s90, 2
    s_add_u32 s69, s69, s76
    s_mul_i32 s69, s69, 14336
    buffer_load_dwordx4 v249, s[28:31], s69 offen lds
L_xe48:
    v_mfma_f32_32x32x16_bf16 v[68:83], v[48:51], v[172:175], v[68:83]
    ds_read_b64_tr_b16 v[44:45], v4 offset:2048
    ds_read_b64_tr_b16 v[46:47], v4 offset:3072
    ds_read_b64_tr_b16 v[48:49], v5 offset:2048
    ds_read_b64_tr_b16 v[50:51], v5 offset:3072
    v_mfma_f32_32x32x16_bf16 v[52:67], v[28:31], v[176:179], v[52:67]
    s_cmp_eq_u32 s1, 0x3800
    s_cbranch_scc1 L_xd49
    s_add_u32 m0, s1, s89
    s_mul_i32 s69, s1, 7
    s_add_u32 s69, s69, s74
    buffer_load_dwordx4 v249, s[44:47], s69 offen lds
    s_branch L_xe49
L_xd49:
    s_add_u32 m0, s89, 0x3800
    s_lshl_b32 s69, s90, 2
    s_add_u32 s69, s69, s76
    s_mul_i32 s69, s69, 14336
    buffer_load_dwordx4 v249, s[28:31], s69 offen lds
L_xe49:
    v_mfma_f32_32x32x16_bf16 v[68:83], v[32:35], v[176:179], v[68:83]
    ds_read_b64_tr_b16 v[28:29], v4 offset:4096
    ds_read_b64_tr_b16 v[30:31], v4 offset:5120
    ds_read_b64_tr_b16 v[32:33], v5 offset:4096
    ds_read_b64_tr_b16 v[34:35], v5 offset:5120
    s_waitcnt lgkmcnt(8)
    s_waitcnt vmcnt(13)
    v_mfma_f32_32x32x16_bf16 v[52:67], v[36:39], v[180:183], v[52:67]
    s_cmp_eq_u32 s3, 0x3800
    s_cbranch_scc1 L_xd50
    s_add_u32 m0, s3, s89
    s_mul_i32 s69, s3, 7
    s_add_u32 s69, s69, s74
    buffer_load_dwordx4 v249, s[44:47], s69 offen lds
    s_branch L_xe50
L_xd50:
    s_add_u32 m0, s89, 0x3800
    s_lshl_b32 s69, s90, 2
    s_add_u32 s69, s69, s76
    s_mul_i32 s69, s69, 14336
    buffer_load_dwordx4 v249, s[28:31], s69 offen lds
L_xe50:
    v_mfma_f32_32x32x16_bf16 v[68:83], v[40:43], v[180:183], v[68:83]
    ds_read_b64_tr_b16 v[36:37], v4 offset:6144
    ds_read_b64_tr_b16 v[38:39], v4 offset:7168
    ds_read_b64_tr_b16 v[40:41], v5 offset:6144
    ds_read_b64_tr_b16 v[42:43], v5 offset:7168
    s_waitcnt lgkmcnt(8)
    s_waitcnt vmcnt(13)
    v_mfma_f32_32x32x16_bf16 v[52:67], v[44:47], v[184:187], v[52:67]
    s_cmp_eq_u32 s13, 0x3800
    s_cbranch_scc1 L_xd51
    s_add_u32 m0, s13, s89
    s_mul_i32 s69, s13, 7
    s_add_u32 s69, s69, s74
    buffer_load_dwordx4 v249, s[44:47], s69 offen lds
    s_branch L_xe51
L_xd51:
    s_add_u32 m0, s89, 0x3800
    s_lshl_b32 s69, s90, 2
    s_add_u32 s69, s69, s76
    s_mul_i32 s69, s69, 14336
    buffer_load_dwordx4 v249, s[28:31], s69 offen lds
L_xe51:
    v_mfma_f32_32x32x16_bf16 v[68:83], v[48:51], v[184:187], v[68:83]
    ds_read_b64_tr_b16 v[44:45], v4 offset:8192
    ds_read_b64_tr_b16 v[46:47], v4 offset:9216
    ds_read_b64_tr_b16 v[48:49], v5 offset:8192
    ds_read_b64_tr_b16 v[50:51], v5 offset:9216
    s_waitcnt lgkmcnt(8)
    s_waitcnt vmcnt(13)
    v_mfma_f32_32x32x16_bf16 v[52:67], v[28:31], v[188:191], v[52:67]
    s_cmp_eq_u32 s14, 0x3800
    s_cbranch_scc1 L_xd52
    s_add_u32 m0, s14, s89
    s_mul_i32 s69, s14, 7
    s_add_u32 s69, s69, s74
    buffer_load_dwordx4 v249, s[44:47], s69 offen lds
    s_branch L_xe52
L_xd52:
    s_add_u32 m0, s89, 0x3800
    s_lshl_b32 s69, s90, 2
    s_add_u32 s69, s69, s76
    s_mul_i32 s69, s69, 14336
    buffer_load_dwordx4 v249, s[28:31], s69 offen lds
L_xe52:
    v_mfma_f32_32x32x16_bf16 v[68:83], v[32:35], v[188:191], v[68:83]
    ds_read_b64_tr_b16 v[28:29], v4 offset:10240
    ds_read_b64_tr_b16 v[30:31], v4 offset:11264
    ds_read_b64_tr_b16 v[32:33], v5 offset:10240
    ds_read_b64_tr_b16 v[34:35], v5 offset:11264
    s_waitcnt lgkmcnt(8)
    s_waitcnt vmcnt(13)
    v_mfma_f32_32x32x16_bf16 v[52:67], v[36:39], v[192:195], v[52:67]
    s_cmp_eq_u32 s15, 0x3800
    s_cbranch_scc1 L_xd53
    s_add_u32 m0, s15, s89
    s_mul_i32 s69, s15, 7
    s_add_u32 s69, s69, s74
    buffer_load_dwordx4 v249, s[44:47], s69 offen lds
    s_branch L_xe53
L_xd53:
    s_add_u32 m0, s89, 0x3800
    s_lshl_b32 s69, s90, 2
    s_add_u32 s69, s69, s76
    s_mul_i32 s69, s69, 14336
    buffer_load_dwordx4 v249, s[28:31], s69 offen lds
L_xe53:
    v_mfma_f32_32x32x16_bf16 v[68:83], v[40:43], v[192:195], v[68:83]
    ds_read_b64_tr_b16 v[36:37], v4 offset:12288
    ds_read_b64_tr_b16 v[38:39], v4 offset:13312
    ds_read_b64_tr_b16 v[40:41], v5 offset:12288
    ds_read_b64_tr_b16 v[42:43], v5 offset:13312
    s_waitcnt lgkmcnt(8)
    s_waitcnt vmcnt(13)
    v_mfma_f32_32x32x16_bf16 v[52:67], v[44:47], v[196:199], v[52:67]
    s_cmp_eq_u32 s22, 0x3800
    s_cbranch_scc1 L_xd54
    s_add_u32 m0, s22, s89
    s_mul_i32 s69, s22, 7
    s_add_u32 s69, s69, s74
    buffer_load_dwordx4 v249, s[44:47], s69 offen lds
    s_branch L_xe54
L_xd54:
    s_add_u32 m0, s89, 0x3800
    s_lshl_b32 s69, s90, 2
    s_add_u32 s69, s69, s76
    s_mul_i32 s69, s69, 14336
    buffer_load_dwordx4 v249, s[28:31], s69 offen lds
L_xe54:
    v_mfma_f32_32x32x16_bf16 v[68:83], v[48:51], v[196:199], v[68:83]
    ds_read_b64_tr_b16 v[44:45], v4 offset:14336
    ds_read_b64_tr_b16 v[46:47], v4 offset:15360
    ds_read_b64_tr_b16 v[48:49], v5 offset:14336
    ds_read_b64_tr_b16 v[50:51], v5 offset:15360
    s_waitcnt lgkmcnt(8)
    s_waitcnt vmcnt(13)
    v_mfma_f32_32x32x16_bf16 v[52:67], v[28:31], v[200:203], v[52:67]
    s_cmp_eq_u32 s23, 0x3800
    s_cbranch_scc1 L_xd55
    s_add_u32 m0, s23, s89
    s_mul_i32 s69, s23, 7
    s_add_u32 s69, s69, s74
    buffer_load_dwordx4 v249, s[44:47], s69 offen lds
    s_branch L_xe55
L_xd55:
    s_add_u32 m0, s89, 0x3800
    s_lshl_b32 s69, s90, 2
    s_add_u32 s69, s69, s76
    s_mul_i32 s69, s69, 14336
    buffer_load_dwordx4 v249, s[28:31], s69 offen lds
L_xe55:
    v_mfma_f32_32x32x16_bf16 v[68:83], v[32:35], v[200:203], v[68:83]
    v_permlane32_swap_b32 v24, v26
    v_permlane32_swap_b32 v25, v27
    ds_read_b64_tr_b16 v[28:29], v8 offset:0
    ds_read_b64_tr_b16 v[30:31], v8 offset:1024
    ds_read_b64_tr_b16 v[32:33], v9 offset:0
    ds_read_b64_tr_b16 v[34:35], v9 offset:1024
    s_waitcnt lgkmcnt(8)
    s_waitcnt vmcnt(13)
    v_mfma_f32_32x32x16_bf16 v[52:67], v[36:39], v[204:207], v[52:67]
    buffer_load_dwordx4 v[228:231], v3, s[36:39], s79 offen offset:0 sc1
    v_mfma_f32_32x32x16_bf16 v[68:83], v[40:43], v[204:207], v[68:83]
    v_bfe_u32 v152, v1, 4, 1
    v_lshlrev_b32 v152, 14, v152
    v_and_b32 v153, 15, v1
    v_lshl_add_u32 v152, v153, 7, v152
    v_lshrrev_b32 v153, 5, v1
    v_lshlrev_b32 v153, 3, v153
    s_lshl_b32 s70, s76, 5
    v_add_u32 v153, s70, v153
    v_and_b32 v154, 2, v1
    v_lshlrev_b32 v154, 5, v154
    v_xor_b32 v153, v153, v154
    s_lshl_b32 s70, s77, 15
    s_add_u32 s70, s70, 79872
    v_add3_u32 v159, v152, v153, s70
    ds_read_b64_tr_b16 v[36:37], v8 offset:2048
    ds_read_b64_tr_b16 v[38:39], v8 offset:3072
    ds_read_b64_tr_b16 v[40:41], v9 offset:2048
    ds_read_b64_tr_b16 v[42:43], v9 offset:3072
    s_waitcnt lgkmcnt(8)
    s_waitcnt vmcnt(13)
    v_mfma_f32_32x32x16_bf16 v[52:67], v[44:47], v[208:211], v[52:67]
    buffer_load_dwordx4 v[232:235], v3, s[36:39], s79 offen offset:1024 sc1
    v_mfma_f32_32x32x16_bf16 v[68:83], v[48:51], v[208:211], v[68:83]
    v_lshlrev_b32 v160, 16, v24
    v_and_b32 v161, 0xffff0000, v24
    v_lshlrev_b32 v162, 16, v25
    v_and_b32 v163, 0xffff0000, v25
    v_lshlrev_b32 v164, 16, v26
    v_and_b32 v165, 0xffff0000, v26
    v_lshlrev_b32 v166, 16, v27
    v_and_b32 v167, 0xffff0000, v27
    ds_read_b64_tr_b16 v[44:45], v8 offset:4096
    ds_read_b64_tr_b16 v[46:47], v8 offset:5120
    ds_read_b64_tr_b16 v[48:49], v9 offset:4096
    ds_read_b64_tr_b16 v[50:51], v9 offset:5120
    s_waitcnt lgkmcnt(8)
    s_waitcnt vmcnt(13)
    v_mfma_f32_32x32x16_bf16 v[52:67], v[28:31], v[212:215], v[52:67]
    buffer_load_dwordx4 v[236:239], v3, s[36:39], s79 offen offset:2048 sc1
    v_mfma_f32_32x32x16_bf16 v[68:83], v[32:35], v[212:215], v[68:83]
    s_lshl_b32 s70, s77, 12
    s_add_u32 s70, s70, 131072
    v_add_u32 v15, s70, v3
    s_xor_b32 s71, s76, 1
    s_lshl_b32 s71, s71, 13
    s_add_u32 s71, s71, 0
    v_add_u32 v248, s71, v15
    s_xor_b32 s71, s76, 2
    s_lshl_b32 s71, s71, 13
    s_add_u32 s71, s71, 2048
    v_add_u32 v250, s71, v15
    s_lshl_b32 s71, s76, 13
    v_add_u32 v18, s71, v15
    s_lshl_b32 s70, s77, 11
    s_add_u32 s70, s70, 12288
    v_add_u32 v15, s70, v3
    s_xor_b32 s71, s76, 3
    s_lshl_b32 s71, s71, 14
    v_add_u32 v2, s71, v15
    s_lshl_b32 s71, s76, 14
    v_add_u32 v19, s71, v15
    ds_read_b64_tr_b16 v[28:29], v8 offset:6144
    ds_read_b64_tr_b16 v[30:31], v8 offset:7168
    ds_read_b64_tr_b16 v[32:33], v9 offset:6144
    ds_read_b64_tr_b16 v[34:35], v9 offset:7168
    s_waitcnt lgkmcnt(8)
    s_waitcnt vmcnt(13)
    v_mfma_f32_32x32x16_bf16 v[52:67], v[36:39], v[216:219], v[52:67]
    buffer_load_dwordx4 v[240:243], v3, s[36:39], s79 offen offset:3072 sc1
    v_mfma_f32_32x32x16_bf16 v[68:83], v[40:43], v[216:219], v[68:83]
    s_waitcnt lgkmcnt(0)
    s_waitcnt vmcnt(4)
    s_barrier
    ds_read_b64_tr_b16 v[36:37], v7 offset:0
    ds_read_b64_tr_b16 v[38:39], v7 offset:2048
    ds_read_b64_tr_b16 v[40:41], v7 offset:1024
    ds_read_b64_tr_b16 v[42:43], v7 offset:3072
    v_mfma_f32_32x32x16_bf16 v[52:67], v[44:47], v[220:223], v[52:67]
    s_add_u32 s70, s79, 4096
    buffer_load_dwordx4 v[244:247], v3, s[36:39], s70 offen offset:0 sc1
    v_mfma_f32_32x32x16_bf16 v[68:83], v[48:51], v[220:223], v[68:83]
    ds_read_b64 v[20:21], v159
    ds_read_b64 v[22:23], v159 offset:16
    ds_read_b64_tr_b16 v[44:45], v7 offset:3584
    ds_read_b64_tr_b16 v[46:47], v7 offset:5632
    ds_read_b64_tr_b16 v[48:49], v7 offset:4608
    ds_read_b64_tr_b16 v[50:51], v7 offset:6656
    v_mfma_f32_32x32x16_bf16 v[52:67], v[28:31], v[224:227], v[52:67]
    s_add_u32 s70, s79, 4096
    buffer_load_dwordx4 v[116:119], v3, s[36:39], s70 offen offset:1024 sc1
    v_mfma_f32_32x32x16_bf16 v[68:83], v[32:35], v[224:227], v[68:83]
    s_waitcnt lgkmcnt(4)
    v_lshlrev_b32 v152, 16, v20
    v_and_b32 v153, 0xffff0000, v20
    v_lshlrev_b32 v154, 16, v21
    v_and_b32 v155, 0xffff0000, v21
    v_lshlrev_b32 v156, 16, v22
    v_and_b32 v157, 0xffff0000, v22
    v_lshlrev_b32 v158, 16, v23
    v_and_b32 v159, 0xffff0000, v23
    ds_read_b64_tr_b16 v[28:29], v7 offset:7168
    ds_read_b64_tr_b16 v[30:31], v7 offset:9216
    ds_read_b64_tr_b16 v[32:33], v7 offset:8192
    ds_read_b64_tr_b16 v[34:35], v7 offset:10240
    s_waitcnt vmcnt(5)
    v_mfma_f32_32x32x16_bf16 v[100:115], v[36:39], v[228:231], 0
    s_add_u32 s70, s79, 4096
    buffer_load_dwordx4 v[120:123], v3, s[36:39], s70 offen offset:2048 sc1
    s_waitcnt vmcnt(5)
    v_mfma_f32_32x32x16_bf16 v[100:115], v[40:43], v[232:235], v[100:115]
    ds_write_b128 v13, v[76:79] offset:0
    ds_write_b128 v13, v[80:83] offset:1024
    ds_write_b128 v12, v[68:71] offset:0
    ds_write_b128 v12, v[72:75] offset:1024
    ds_read_b64_tr_b16 v[36:37], v7 offset:10752
    ds_read_b64_tr_b16 v[38:39], v7 offset:12800
    ds_read_b64_tr_b16 v[40:41], v7 offset:11776
    ds_read_b64_tr_b16 v[42:43], v7 offset:13824
    s_waitcnt lgkmcnt(12)
    s_waitcnt vmcnt(4)
    v_mfma_f32_32x32x16_bf16 v[100:115], v[44:47], v[236:239], v[100:115]
    s_add_u32 s70, s79, 4096
    buffer_load_dwordx4 v[124:127], v3, s[36:39], s70 offen offset:3072 sc1
    s_waitcnt vmcnt(4)
    v_mfma_f32_32x32x16_bf16 v[100:115], v[48:51], v[240:243], v[100:115]
    ds_write_b128 v11, v[60:63] offset:0
    ds_write_b128 v11, v[64:67] offset:1024
    v_add_f32 v160, v160, v52
    v_add_f32 v161, v161, v53
    v_add_f32 v162, v162, v54
    v_add_f32 v163, v163, v55
    v_add_f32 v164, v164, v56
    v_add_f32 v165, v165, v57
    v_add_f32 v166, v166, v58
    v_add_f32 v167, v167, v59
    ds_read_b64_tr_b16 v[44:45], v6 offset:0
    ds_read_b64_tr_b16 v[46:47], v6 offset:2048
    ds_read_b64_tr_b16 v[48:49], v6 offset:1024
    ds_read_b64_tr_b16 v[50:51], v6 offset:3072
    s_waitcnt lgkmcnt(14)
    s_waitcnt vmcnt(3)
    v_mfma_f32_32x32x16_bf16 v[100:115], v[28:31], v[244:247], v[100:115]
    s_waitcnt vmcnt(2)
    v_mfma_f32_32x32x16_bf16 v[100:115], v[32:35], v[116:119], v[100:115]
    s_waitcnt lgkmcnt(4)
    s_barrier
    ds_read_b128 v[128:131], v14 offset:0
    ds_read_b128 v[132:135], v14 offset:1024
    ds_read_b128 v[136:139], v14 offset:2048
    ds_read_b128 v[140:143], v14 offset:3072
    ds_read_b128 v[144:147], v14 offset:4096
    ds_read_b128 v[148:151], v14 offset:5120
    ds_read_b64_tr_b16 v[28:29], v6 offset:3584
    ds_read_b64_tr_b16 v[30:31], v6 offset:5632
    ds_read_b64_tr_b16 v[32:33], v6 offset:4608
    ds_read_b64_tr_b16 v[34:35], v6 offset:6656
    s_waitcnt vmcnt(1)
    v_mfma_f32_32x32x16_bf16 v[100:115], v[36:39], v[120:123], v[100:115]
    s_waitcnt vmcnt(0)
    v_mfma_f32_32x32x16_bf16 v[100:115], v[40:43], v[124:127], v[100:115]
    ds_read_b64_tr_b16 v[36:37], v6 offset:7168
    ds_read_b64_tr_b16 v[38:39], v6 offset:9216
    ds_read_b64_tr_b16 v[40:41], v6 offset:8192
    ds_read_b64_tr_b16 v[42:43], v6 offset:10240
    s_waitcnt lgkmcnt(14)
    v_mfma_f32_32x32x16_bf16 v[84:99], v[44:47], v[228:231], 0
    v_mfma_f32_32x32x16_bf16 v[84:99], v[48:51], v[232:235], v[84:99]
    s_waitcnt lgkmcnt(8)
    v_add_f32 v160, v160, v128
    v_add_f32 v161, v161, v129
    v_add_f32 v162, v162, v130
    v_add_f32 v163, v163, v131
    v_add_f32 v164, v164, v132
    v_add_f32 v165, v165, v133
    v_add_f32 v166, v166, v134
    v_add_f32 v167, v167, v135
    v_add_f32 v168, v136, v144
    v_add_f32 v169, v137, v145
    v_add_f32 v170, v138, v146
    v_add_f32 v171, v139, v147
    v_add_f32 v172, v140, v148
    v_add_f32 v173, v141, v149
    v_add_f32 v174, v142, v150
    v_add_f32 v175, v143, v151
    v_add_f32 v160, v160, v168
    v_add_f32 v161, v161, v169
    v_add_f32 v162, v162, v170
    v_add_f32 v163, v163, v171
    v_add_f32 v164, v164, v172
    v_add_f32 v165, v165, v173
    v_add_f32 v166, v166, v174
    v_add_f32 v167, v167, v175
    ds_read_b64_tr_b16 v[44:45], v6 offset:10752
    ds_read_b64_tr_b16 v[46:47], v6 offset:12800
    ds_read_b64_tr_b16 v[48:49], v6 offset:11776
    ds_read_b64_tr_b16 v[50:51], v6 offset:13824
    s_waitcnt lgkmcnt(8)
    v_mfma_f32_32x32x16_bf16 v[84:99], v[28:31], v[236:239], v[84:99]
    v_mfma_f32_32x32x16_bf16 v[84:99], v[32:35], v[240:243], v[84:99]
    ds_write_b128 v2, v[108:111] offset:0
    ds_write_b128 v2, v[112:115] offset:1024
    v_mul_f32 v168, 0xbfb8aa3b, v160
    v_mul_f32 v169, 0xbfb8aa3b, v161
    v_mul_f32 v170, 0xbfb8aa3b, v162
    v_mul_f32 v171, 0xbfb8aa3b, v163
    v_mul_f32 v172, 0xbfb8aa3b, v164
    v_mul_f32 v173, 0xbfb8aa3b, v165
    v_mul_f32 v174, 0xbfb8aa3b, v166
    v_mul_f32 v175, 0xbfb8aa3b, v167
    v_exp_f32 v168, v168
    v_exp_f32 v169, v169
    v_exp_f32 v170, v170
    v_exp_f32 v171, v171
    v_exp_f32 v172, v172
    v_exp_f32 v173, v173
    v_exp_f32 v174, v174
    v_exp_f32 v175, v175
    s_waitcnt lgkmcnt(6)
    v_mfma_f32_32x32x16_bf16 v[84:99], v[36:39], v[244:247], v[84:99]
    v_mfma_f32_32x32x16_bf16 v[84:99], v[40:43], v[116:119], v[84:99]
    ds_write_b128 v250, v[100:103] offset:0
    ds_write_b128 v250, v[104:107] offset:1024
    v_add_f32 v168, 1.0, v168
    v_add_f32 v169, 1.0, v169
    v_add_f32 v170, 1.0, v170
    v_add_f32 v171, 1.0, v171
    v_add_f32 v172, 1.0, v172
    v_add_f32 v173, 1.0, v173
    v_add_f32 v174, 1.0, v174
    v_add_f32 v175, 1.0, v175
    v_rcp_f32 v168, v168
    v_rcp_f32 v169, v169
    v_rcp_f32 v170, v170
    v_rcp_f32 v171, v171
    v_rcp_f32 v172, v172
    v_rcp_f32 v173, v173
    v_rcp_f32 v174, v174
    v_rcp_f32 v175, v175
    s_waitcnt lgkmcnt(4)
    v_mfma_f32_32x32x16_bf16 v[84:99], v[44:47], v[120:123], v[84:99]
    v_mfma_f32_32x32x16_bf16 v[84:99], v[48:51], v[124:127], v[84:99]
    v_mul_f32 v168, v168, v160
    v_mul_f32 v169, v169, v161
    v_mul_f32 v170, v170, v162
    v_mul_f32 v171, v171, v163
    v_mul_f32 v172, v172, v164
    v_mul_f32 v173, v173, v165
    v_mul_f32 v174, v174, v166
    v_mul_f32 v175, v175, v167
    s_nop 3
    ds_write_b128 v248, v[92:95] offset:0
    ds_write_b128 v248, v[96:99] offset:1024
    v_pk_fma_f32 v[152:153], v[168:169], v[84:85], v[152:153]
    v_pk_fma_f32 v[154:155], v[170:171], v[86:87], v[154:155]
    v_pk_fma_f32 v[156:157], v[172:173], v[88:89], v[156:157]
    v_pk_fma_f32 v[158:159], v[174:175], v[90:91], v[158:159]
    s_waitcnt lgkmcnt(0)
    s_barrier
    ds_read_b128 v[128:131], v18 offset:0
    ds_read_b128 v[132:135], v18 offset:1024
    ds_read_b128 v[136:139], v18 offset:2048
    ds_read_b128 v[140:143], v18 offset:3072
    ds_read_b128 v[144:147], v19 offset:0
    ds_read_b128 v[148:151], v19 offset:1024
    s_waitcnt lgkmcnt(2)
    v_pk_add_f32 v[128:129], v[128:129], v[136:137]
    v_pk_add_f32 v[130:131], v[130:131], v[138:139]
    v_pk_add_f32 v[132:133], v[132:133], v[140:141]
    v_pk_add_f32 v[134:135], v[134:135], v[142:143]
    s_waitcnt lgkmcnt(0)
    v_pk_add_f32 v[128:129], v[128:129], v[144:145]
    v_pk_add_f32 v[130:131], v[130:131], v[146:147]
    v_pk_add_f32 v[132:133], v[132:133], v[148:149]
    v_pk_add_f32 v[134:135], v[134:135], v[150:151]
    v_pk_fma_f32 v[152:153], v[168:169], v[128:129], v[152:153]
    v_pk_fma_f32 v[154:155], v[170:171], v[130:131], v[154:155]
    v_pk_fma_f32 v[156:157], v[172:173], v[132:133], v[156:157]
    v_pk_fma_f32 v[158:159], v[174:175], v[134:135], v[158:159]
    v_cvt_pk_bf16_f32 v20, v152, v153
    v_cvt_pk_bf16_f32 v21, v154, v155
    v_cvt_pk_bf16_f32 v22, v156, v157
    v_cvt_pk_bf16_f32 v23, v158, v159
    s_nop 0
    v_permlane32_swap_b32 v20, v22
    v_permlane32_swap_b32 v21, v23
    buffer_store_dwordx4 v[20:23], v10, s[52:55], 0 offen
    s_branch L_s2_skip
L_nos2:
    s_waitcnt vmcnt(0)
    s_barrier
    s_cmp_eq_u32 s64, 4
    s_cbranch_scc0 L_svc56
    s_lshl_b32 s69, s67, 7
    s_add_u32 s69, s69, 9439232
    s_lshr_b32 s70, s66, 4
    s_lshl_b32 s70, s70, 31
    s_lshl_b32 s70, s70, 1
    s_add_u32 s69, s69, s70
    v_mov_b32 v253, 1
    s_mov_b64 exec, 1
    buffer_atomic_add v253, off, s[36:39], s69 sc1
    s_mov_b64 exec, -1
L_svc56:
L_s2_skip:
L_end:
    s_endpgm
L_code_end:
.section .rodata,"a"
.p2align 6
.amdhsa_kernel recurrent_scan__sliding_local_dilated__mixer_channel_mlp__prompt_kernel
  .amdhsa_next_free_vgpr 256
  .amdhsa_next_free_sgpr 102
  .amdhsa_accum_offset 256
  .amdhsa_group_segment_fixed_size 0
  .amdhsa_kernarg_size 88
  .amdhsa_user_sgpr_count 2
  .amdhsa_user_sgpr_kernarg_segment_ptr 1
  .amdhsa_system_sgpr_workgroup_id_x 1
  .amdhsa_float_denorm_mode_32 3
.end_amdhsa_kernel
```
